```python
import torch

def _softmax(x, axis=-1):
    return torch.softmax(x, dim=axis)
def _gelu(x):
    return torch.nn.functional.gelu(x, approximate="tanh")
def _silu(x):
    return torch.nn.functional.silu(x)
def _sigmoid(x):
    return torch.sigmoid(x)
def _layernorm(x, axis=-1, eps=1e-5):
    m = x.mean(dim=axis, keepdim=True)
    v = x.var(dim=axis, keepdim=True, unbiased=False)
    return (x - m) / torch.sqrt(v + eps)
def _scatter_add(tgt, idx, src, axis=0):
    return tgt.clone().index_add_(axis, idx, src)
def _segment_sum(src, seg, n):
    out = torch.zeros((n,) + src.shape[1:], dtype=src.dtype)
    return out.index_add_(0, seg, src)
def _pad(x, pw):
    flat = tuple(v for pair in reversed(pw) for v in pair)
    return torch.nn.functional.pad(x, flat)

kernel_name = 'parallel_sum__ssm_conv_s4__swiglu_ffn__prompt'

def setup_inputs():

    _w = (lambda a: (lambda t: t.to(torch.bfloat16) if t.is_floating_point() else t)(torch.as_tensor(a)))
    def _A_setup():
        B, L, D, N = 1, 2048, 512, 128
        A_re = -(lambda _x: torch.exp(torch.as_tensor(_x)))((lambda *s: torch.randn(*s, dtype=torch.bfloat16) * 3.2)(D, N))
        A_im = torch.pi * (lambda *s: torch.randn(*s, dtype=torch.bfloat16) * 0.1)(D, N)
        B_re = (lambda *s: torch.randn(*s, dtype=torch.bfloat16) * 0.4)(D, N)
        B_im = (lambda *s: torch.randn(*s, dtype=torch.bfloat16) * 0.4)(D, N)
        C_re = (lambda *s: torch.randn(*s, dtype=torch.bfloat16) * 0.4)(D, N)
        C_im = (lambda *s: torch.randn(*s, dtype=torch.bfloat16) * 0.4)(D, N)
        log_dt = (lambda *s: torch.randn(*s, dtype=torch.bfloat16) * 0.1)(D) * 0.5 - 4.0
        Dskip = (lambda *s: torch.randn(*s, dtype=torch.bfloat16) * 0.2)(D)
        return {
            "u": _w((lambda *s: torch.randn(*s, dtype=torch.bfloat16) * 0.05)(B, L, D)),
            "A_re": _w(A_re),
            "A_im": _w(A_im),
            "B_re": _w(B_re),
            "B_im": _w(B_im),
            "C_re": _w(C_re),
            "C_im": _w(C_im),
            "log_dt": _w(log_dt),
            "Dskip": _w(Dskip),
        }
    _A_in = _A_setup()

    def _B_setup():
        B, S, D, F = 1, 2048, 512, 1376
        return {
            "x": _w((lambda *s: torch.randn(*s, dtype=torch.bfloat16) * 0.05)(B, S, D)),
            "w_gate": _w((lambda *s: torch.randn(*s, dtype=torch.bfloat16) * 0.05)(D, F)),
            "w_up": _w((lambda *s: torch.randn(*s, dtype=torch.bfloat16) * 0.05)(D, F)),
            "w_down": _w((lambda *s: torch.randn(*s, dtype=torch.bfloat16) * 0.05)(F, D)),
        }
    _B_in = _B_setup()

    return {
        "A_u": _A_in["u"],
        "A_A_re": _A_in["A_re"],
        "A_A_im": _A_in["A_im"],
        "A_B_re": _A_in["B_re"],
        "A_B_im": _A_in["B_im"],
        "A_C_re": _A_in["C_re"],
        "A_C_im": _A_in["C_im"],
        "A_log_dt": _A_in["log_dt"],
        "A_Dskip": _A_in["Dskip"],
        "B_x": _B_in["x"],
        "B_w_gate": _B_in["w_gate"],
        "B_w_up": _B_in["w_up"],
        "B_w_down": _B_in["w_down"],
    }

def reference(A_u, A_A_re, A_A_im, A_B_re, A_B_im, A_C_re, A_C_im, A_log_dt, A_Dskip, B_x, B_w_gate, B_w_up, B_w_down):
    def _A_ref(u, A_re, A_im, B_re, B_im, C_re, C_im, log_dt, Dskip):
        Bsz, L, D = u.shape
        dt = torch.exp(log_dt)[:, None]
        A = A_re + 1j * A_im
        Bc = B_re + 1j * B_im
        Cc = C_re + 1j * C_im
        logdA = dt * A
        dB = dt * Bc
        l = (lambda x, dt: x.to(dt))(torch.arange(L), A_re.dtype)
        P = torch.exp(logdA[:, :, None] * l[None, None, :])
        K = torch.einsum("dn,dnl,dn->dl", Cc, P, dB).real
        L2 = 2 * L
        Kp = _pad(K, ((0, 0), (0, L)))
        up = (lambda x, *d: x.permute(*d))(u, 0, 2, 1)
        up = _pad(up, ((0, 0), (0, 0), (0, L)))
        Kf = (lambda x, axes=(-2,-1): torch.fft.rfft2(x.float(), dim=axes))(Kp[:, None, :], axes=(-2, -1))
        Uf = (lambda x, axes=(-2,-1): torch.fft.rfft2(x.float(), dim=axes))(up[:, :, None, :], axes=(-2, -1))
        Yf = Uf * Kf[None, :, :, :]
        y = (lambda x, s, axes=(-2,-1): torch.fft.irfft2(x, s=s, dim=axes).to(torch.bfloat16))(Yf, (1, L2), axes=(-2, -1))[:, :, 0, :L]
        y = (lambda x, *d: x.permute(*d))(y, 0, 2, 1) + u * Dskip[None, None, :]
        return y

    def _B_ref(x, w_gate, w_up, w_down):
        g = _silu(x @ w_gate)
        u = x @ w_up
        return (g * u) @ w_down

    x = A_u
    xn = _layernorm(x, axis=-1)
    return x + _A_ref(xn, A_A_re, A_A_im, A_B_re, A_B_im, A_C_re, A_C_im, A_log_dt, A_Dskip) + _B_ref(xn, B_w_gate, B_w_up, B_w_down)
```

```asm
; @launch grid=(512,1,1) block=(256,1,1) lds=81920
.amdgcn_target "amdgcn-amd-amdhsa--gfx950"
.text
.globl parallel_sum__ssm_conv_s4__swiglu_ffn__prompt_kernel
.p2align 8
.type parallel_sum__ssm_conv_s4__swiglu_ffn__prompt_kernel,@function
parallel_sum__ssm_conv_s4__swiglu_ffn__prompt_kernel:
    s_load_dwordx16 s[16:31], s[0:1], 0
    s_load_dwordx16 s[32:47], s[0:1], 64
    s_cmp_ge_u32 s2, 512
    s_cbranch_scc1 L_end3
    s_xor_b32 s2, s2, 256
    s_cmp_ge_u32 s2, 256
    s_cbranch_scc1 L_prep
    s_and_b32 s3, s2, 7
    s_lshr_b32 s13, s2, 3
    v_lshrrev_b32 v2, 6, v0
    v_and_b32 v1, 63, v0
    s_lshr_b32 s4, s3, 1
    s_lshl_b32 s4, s4, 2
    v_readfirstlane_b32 s6, v2
    s_and_b32 s5, s13, 3
    s_add_u32 s4, s4, s5
    s_and_b32 s5, s3, 1
    s_lshl_b32 s5, s5, 3
    s_lshr_b32 s13, s13, 2
    s_add_u32 s5, s5, s13
    s_cmp_ge_u32 s5, 15
    s_cselect_b32 s68, 1, 0
    s_cselect_b32 s5, s4, s5
    s_cmp_ge_u32 s5, 15
    s_cbranch_scc1 L_idle
    s_setprio 2
    s_and_b32 s7, s6, 1
    s_lshr_b32 s8, s6, 1
    v_bfe_u32 v23, v1, 2, 2
    v_lshrrev_b32 v20, 4, v1
    v_and_b32 v22, 3, v1
    s_mul_i32 s14, s5, 192
    s_mul_i32 s15, s7, 44032
    s_add_u32 s14, s14, s15
    s_movk_i32 s65, 2752
    s_cmp_eq_u32 s5, 14
    s_cselect_b32 s66, 0x400000, 64
    v_add_u32 v25, 0, v20
    v_mul_u32_u24 v21, 11, v25
    v_lshrrev_b32 v21, 5, v21
    v_mul_u32_u24 v24, 3, v21
    v_sub_u32 v24, v25, v24
    v_and_b32 v25, 2, v21
    v_xor_b32 v25, v25, v22
    v_lshl_add_u32 v21, v21, 2, v23
    v_mul_u32_u24 v21, s65, v21
    v_mul_u32_u24 v24, s66, v24
    v_add_u32 v21, v24, v21
    v_lshl_add_u32 v21, v25, 4, v21
    v_add3_u32 v6, v21, s14, 0
    v_add_u32 v25, 4, v20
    v_mul_u32_u24 v21, 11, v25
    v_lshrrev_b32 v21, 5, v21
    v_mul_u32_u24 v24, 3, v21
    v_sub_u32 v24, v25, v24
    v_and_b32 v25, 2, v21
    v_xor_b32 v25, v25, v22
    v_lshl_add_u32 v21, v21, 2, v23
    v_mul_u32_u24 v21, s65, v21
    v_mul_u32_u24 v24, s66, v24
    v_add_u32 v21, v24, v21
    v_lshl_add_u32 v21, v25, 4, v21
    v_add_u32 v21, s14, v21
    v_subrev_u32 v7, 1024, v21
    v_add_u32 v25, 8, v20
    v_mul_u32_u24 v21, 11, v25
    v_lshrrev_b32 v21, 5, v21
    v_mul_u32_u24 v24, 3, v21
    v_sub_u32 v24, v25, v24
    v_and_b32 v25, 2, v21
    v_xor_b32 v25, v25, v22
    v_lshl_add_u32 v21, v21, 2, v23
    v_mul_u32_u24 v21, s65, v21
    v_mul_u32_u24 v24, s66, v24
    v_add_u32 v21, v24, v21
    v_lshl_add_u32 v21, v25, 4, v21
    v_add_u32 v21, s14, v21
    v_subrev_u32 v8, 2048, v21
    v_lshrrev_b32 v21, 3, v1
    s_lshl_b32 s3, s6, 15
    v_lshlrev_b32 v21, 10, v21
    v_and_b32 v22, 7, v1
    v_xor_b32 v22, v20, v22
    v_lshl_add_u32 v21, v22, 4, v21
    v_add_u32 v2, s3, v21
    v_xor_b32 v3, 64, v2
    v_add_u32 v3, 7168, v3
    v_add_u32 v4, 14336, v2
    v_add_u32 v5, 14336, v3
    s_lshl_b32 s9, s6, 12
    s_mul_i32 s10, s6, 3072
    s_add_u32 s10, s10, 32768
    s_lshl_b32 s3, s4, 17
    s_and_b32 s67, s4, 12
    s_and_b32 s11, s5, 8
    s_add_u32 s67, s67, s11
    s_and_b32 s67, s67, 15
    s_lshl_b32 s11, s67, 6
    s_mul_i32 s12, s67, 88064
    s_mov_b32 s50, 131072
    s_mov_b32 s51, 0x00020000
    s_mov_b32 s54, 1409024
    s_mov_b32 s55, 0x00020000
    s_cmp_eq_u32 s8, 0
    s_waitcnt lgkmcnt(0)
    s_cselect_b32 s52, s36, s38
    s_cselect_b32 s53, s37, s39
    s_add_u32 s48, s16, s3
    s_addc_u32 s49, s17, 0
    s_add_u32 m0, s10, 0
    s_nop 0
    buffer_load_dwordx4 v6, s[52:55], s12 offen offset:0 lds
    buffer_load_dwordx4 v7, s[52:55], s12 offen offset:1024 lds
    buffer_load_dwordx4 v8, s[52:55], s12 offen offset:2048 lds
    s_add_u32 s67, s67, 1
    s_and_b32 s67, s67, 15
    s_mul_i32 s12, s67, 88064
    s_cmp_lg_u32 s68, 0
    s_cbranch_scc1 L_g1nox
    s_add_u32 m0, s9, 0
    s_nop 0
    buffer_load_dwordx4 v2, s[48:51], s11 offen offset:0 lds
    buffer_load_dwordx4 v3, s[48:51], s11 offen offset:1024 lds
    buffer_load_dwordx4 v4, s[48:51], s11 offen offset:2048 lds
    buffer_load_dwordx4 v5, s[48:51], s11 offen offset:3072 lds
    s_add_u32 s11, s11, 128
    s_and_b32 s11, s11, 1023
    s_add_u32 m0, s10, 12288
    s_nop 0
    buffer_load_dwordx4 v6, s[52:55], s12 offen offset:0 lds
    buffer_load_dwordx4 v7, s[52:55], s12 offen offset:1024 lds
    buffer_load_dwordx4 v8, s[52:55], s12 offen offset:2048 lds
    s_add_u32 s67, s67, 1
    s_and_b32 s67, s67, 15
    s_mul_i32 s12, s67, 88064
    s_add_u32 m0, s9, 16384
    s_nop 0
    buffer_load_dwordx4 v2, s[48:51], s11 offen offset:0 lds
    buffer_load_dwordx4 v3, s[48:51], s11 offen offset:1024 lds
    buffer_load_dwordx4 v4, s[48:51], s11 offen offset:2048 lds
    buffer_load_dwordx4 v5, s[48:51], s11 offen offset:3072 lds
    s_add_u32 s11, s11, 128
    s_and_b32 s11, s11, 1023
    s_add_u32 m0, s10, 24576
    s_nop 0
    buffer_load_dwordx4 v6, s[52:55], s12 offen offset:0 lds
    buffer_load_dwordx4 v7, s[52:55], s12 offen offset:1024 lds
    buffer_load_dwordx4 v8, s[52:55], s12 offen offset:2048 lds
    s_add_u32 s67, s67, 1
    s_and_b32 s67, s67, 15
    s_mul_i32 s12, s67, 88064
    s_branch L_g1x
L_g1nox:
    s_add_u32 m0, s10, 12288
    s_nop 0
    buffer_load_dwordx4 v6, s[52:55], s12 offen offset:0 lds
    buffer_load_dwordx4 v7, s[52:55], s12 offen offset:1024 lds
    buffer_load_dwordx4 v8, s[52:55], s12 offen offset:2048 lds
    s_add_u32 s67, s67, 1
    s_and_b32 s67, s67, 15
    s_mul_i32 s12, s67, 88064
    s_add_u32 m0, s10, 24576
    s_nop 0
    buffer_load_dwordx4 v6, s[52:55], s12 offen offset:0 lds
    buffer_load_dwordx4 v7, s[52:55], s12 offen offset:1024 lds
    buffer_load_dwordx4 v8, s[52:55], s12 offen offset:2048 lds
    s_add_u32 s67, s67, 1
    s_and_b32 s67, s67, 15
    s_mul_i32 s12, s67, 88064
L_g1x:
    v_and_b32 v21, 15, v1
    v_bfe_u32 v22, v1, 1, 3
    v_xor_b32 v22, v20, v22
    v_lshlrev_b32 v22, 4, v22
    v_lshl_add_u32 v22, v21, 7, v22
    s_lshl_b32 s3, s7, 13
    s_lshl_b32 s14, s8, 12
    s_add_u32 s3, s3, s14
    v_add_u32 v9, s3, v22
    v_xor_b32 v10, 0x1000, v9
    v_xor_b32 v11, 64, v9
    v_xor_b32 v12, 0x1040, v9
    v_mul_u32_u24 v22, 1536, v20
    v_lshl_add_u32 v22, v23, 6, v22
    v_and_b32 v24, 1, v20
    v_lshl_add_u32 v22, v24, 5, v22
    v_and_b32 v24, 3, v1
    v_lshl_add_u32 v22, v24, 3, v22
    s_lshl_b32 s3, s8, 9
    s_add_u32 s3, s3, 32768
    v_add_u32 v13, s3, v22
    v_xor_b32 v14, 32, v13
    s_lshl_b32 s3, s8, 5
    v_xor_b32 v22, s3, v22
    v_add_u32 v15, 33024, v22
    s_cmp_lg_u32 s68, 0
    s_cbranch_scc1 L_cs
    v_mov_b32 v56, 0
    v_mov_b32 v57, 0
    v_mov_b32 v58, 0
    v_mov_b32 v59, 0
    v_mov_b32 v60, 0
    v_mov_b32 v61, 0
    v_mov_b32 v62, 0
    v_mov_b32 v63, 0
    v_mov_b32 v80, 0
    v_mov_b32 v81, 0
    v_mov_b32 v82, 0
    v_mov_b32 v83, 0
    v_mov_b32 v84, 0
    v_mov_b32 v85, 0
    v_mov_b32 v86, 0
    v_mov_b32 v87, 0
    v_mov_b32 v104, 0
    v_mov_b32 v105, 0
    v_mov_b32 v106, 0
    v_mov_b32 v107, 0
    v_mov_b32 v108, 0
    v_mov_b32 v109, 0
    v_mov_b32 v110, 0
    v_mov_b32 v111, 0
    v_mov_b32 v128, 0
    v_mov_b32 v129, 0
    v_mov_b32 v130, 0
    v_mov_b32 v131, 0
    v_mov_b32 v132, 0
    v_mov_b32 v133, 0
    v_mov_b32 v134, 0
    v_mov_b32 v135, 0
    s_add_u32 s90, s46, 15990784
    s_addc_u32 s91, s47, 0
    v_min_u32 v26, 3, v1
    s_lshl_b32 s3, s4, 6
    v_lshl_add_u32 v26, v26, 4, s3
    s_lshl_b32 s14, s5, 4
    s_add_u32 s14, s14, 4096
    v_mov_b32 v32, 0
    v_writelane_b32 v26, s14, 4
    s_add_u32 s60, s46, 15859712
    s_addc_u32 s61, s47, 0
    s_add_u32 s62, s46, 15925248
    s_addc_u32 s63, s47, 0
    s_lshl_b32 s3, s4, 11
    s_lshl_b32 s14, s7, 10
    s_add_u32 s3, s3, s14
    s_lshl_b32 s14, s8, 9
    s_add_u32 s3, s3, s14
    v_lshl_add_u32 v29, v21, 4, s3
    v_xor_b32 v30, 0x200, v29
    s_mul_i32 s3, s5, 768
    s_mul_i32 s14, s8, 384
    s_add_u32 s3, s3, s14
    v_lshl_add_u32 v31, v20, 4, s3
    s_mov_b32 s13, 3
    s_waitcnt vmcnt(10) lgkmcnt(0)
    s_barrier
    ds_read_b128 v[136:139], v9 offset:0
    ds_read_b128 v[140:143], v9 offset:2048
    ds_read_b128 v[144:147], v10 offset:0
    ds_read_b128 v[148:151], v10 offset:2048
    ds_read_b64_tr_b16 v[200:201], v13 offset:0
    ds_read_b64_tr_b16 v[202:203], v13 offset:768
    ds_read_b64_tr_b16 v[204:205], v13 offset:6144
    ds_read_b64_tr_b16 v[206:207], v13 offset:6912
    s_waitcnt lgkmcnt(2)
    v_mfma_f32_16x16x32_bf16 v[40:43], v[200:203], v[136:139], 0
    s_add_u32 m0, s10, 36864
    ds_read_b128 v[152:155], v11 offset:0
    v_mfma_f32_16x16x32_bf16 v[64:67], v[200:203], v[140:143], 0
    ds_read_b128 v[156:159], v11 offset:2048
    ds_read_b64_tr_b16 v[208:209], v14 offset:0
    v_mfma_f32_16x16x32_bf16 v[88:91], v[200:203], v[144:147], 0
    ds_read_b64_tr_b16 v[210:211], v14 offset:768
    buffer_load_dwordx4 v6, s[52:55], s12 offen offset:0 lds
    v_mfma_f32_16x16x32_bf16 v[112:115], v[200:203], v[148:151], 0
    s_waitcnt lgkmcnt(2)
    v_mfma_f32_16x16x32_bf16 v[44:47], v[204:207], v[136:139], 0
    ds_read_b128 v[160:163], v12 offset:0
    ds_read_b128 v[164:167], v12 offset:2048
    v_mfma_f32_16x16x32_bf16 v[68:71], v[204:207], v[140:143], 0
    ds_read_b64_tr_b16 v[212:213], v14 offset:6144
    ds_read_b64_tr_b16 v[214:215], v14 offset:6912
    v_mfma_f32_16x16x32_bf16 v[92:95], v[204:207], v[144:147], 0
    buffer_load_dwordx4 v7, s[52:55], s12 offen offset:1024 lds
    buffer_load_dwordx4 v8, s[52:55], s12 offen offset:2048 lds
    v_mfma_f32_16x16x32_bf16 v[116:119], v[204:207], v[148:151], 0
    s_waitcnt lgkmcnt(2)
    v_mfma_f32_16x16x32_bf16 v[48:51], v[208:211], v[136:139], 0
    ds_read_b64_tr_b16 v[216:217], v15 offset:0
    ds_read_b64_tr_b16 v[218:219], v15 offset:768
    v_mfma_f32_16x16x32_bf16 v[72:75], v[208:211], v[140:143], 0
    s_add_u32 s67, s67, 1
    s_and_b32 s67, s67, 15
    v_mfma_f32_16x16x32_bf16 v[96:99], v[208:211], v[144:147], 0
    s_mul_i32 s12, s67, 88064
    v_mfma_f32_16x16x32_bf16 v[120:123], v[208:211], v[148:151], 0
    s_waitcnt lgkmcnt(2)
    v_mfma_f32_16x16x32_bf16 v[52:55], v[212:215], v[136:139], 0
    ds_read_b64_tr_b16 v[220:221], v15 offset:6144
    ds_read_b64_tr_b16 v[222:223], v15 offset:6912
    v_mfma_f32_16x16x32_bf16 v[76:79], v[212:215], v[140:143], 0
    v_mfma_f32_16x16x32_bf16 v[100:103], v[212:215], v[144:147], 0
    v_mfma_f32_16x16x32_bf16 v[124:127], v[212:215], v[148:151], 0
L_g1loop:
    s_waitcnt vmcnt(10) lgkmcnt(0)
    s_barrier
    v_mfma_f32_16x16x32_bf16 v[56:59], v[216:219], v[136:139], v[56:59]
    s_add_u32 m0, s9, 0
    ds_read_b64_tr_b16 v[200:201], v13 offset:12288
    v_mfma_f32_16x16x32_bf16 v[80:83], v[216:219], v[140:143], v[80:83]
    buffer_load_dwordx4 v2, s[48:51], s11 offen offset:0 lds
    ds_read_b64_tr_b16 v[202:203], v13 offset:13056
    v_mfma_f32_16x16x32_bf16 v[104:107], v[216:219], v[144:147], v[104:107]
    buffer_load_dwordx4 v3, s[48:51], s11 offen offset:1024 lds
    ds_read_b64_tr_b16 v[204:205], v13 offset:18432
    v_mfma_f32_16x16x32_bf16 v[128:131], v[216:219], v[148:151], v[128:131]
    buffer_load_dwordx4 v4, s[48:51], s11 offen offset:2048 lds
    ds_read_b64_tr_b16 v[206:207], v13 offset:19200
    v_mfma_f32_16x16x32_bf16 v[60:63], v[220:223], v[136:139], v[60:63]
    buffer_load_dwordx4 v5, s[48:51], s11 offen offset:3072 lds
    s_add_u32 s11, s11, 128
    v_mfma_f32_16x16x32_bf16 v[84:87], v[220:223], v[140:143], v[84:87]
    s_and_b32 s11, s11, 1023
    v_mfma_f32_16x16x32_bf16 v[108:111], v[220:223], v[144:147], v[108:111]
    v_mfma_f32_16x16x32_bf16 v[132:135], v[220:223], v[148:151], v[132:135]
    s_waitcnt lgkmcnt(2)
    v_mfma_f32_16x16x32_bf16 v[40:43], v[200:203], v[152:155], v[40:43]
    s_add_u32 m0, s10, 0
    ds_read_b64_tr_b16 v[208:209], v14 offset:12288
    v_mfma_f32_16x16x32_bf16 v[64:67], v[200:203], v[156:159], v[64:67]
    ds_read_b64_tr_b16 v[210:211], v14 offset:13056
    buffer_load_dwordx4 v6, s[52:55], s12 offen offset:0 lds
    v_mfma_f32_16x16x32_bf16 v[88:91], v[200:203], v[160:163], v[88:91]
    v_mfma_f32_16x16x32_bf16 v[112:115], v[200:203], v[164:167], v[112:115]
    s_waitcnt lgkmcnt(2)
    v_mfma_f32_16x16x32_bf16 v[44:47], v[204:207], v[152:155], v[44:47]
    ds_read_b64_tr_b16 v[212:213], v14 offset:18432
    ds_read_b64_tr_b16 v[214:215], v14 offset:19200
    v_mfma_f32_16x16x32_bf16 v[68:71], v[204:207], v[156:159], v[68:71]
    buffer_load_dwordx4 v7, s[52:55], s12 offen offset:1024 lds
    buffer_load_dwordx4 v8, s[52:55], s12 offen offset:2048 lds
    v_mfma_f32_16x16x32_bf16 v[92:95], v[204:207], v[160:163], v[92:95]
    v_mfma_f32_16x16x32_bf16 v[116:119], v[204:207], v[164:167], v[116:119]
    s_waitcnt lgkmcnt(2)
    v_mfma_f32_16x16x32_bf16 v[48:51], v[208:211], v[152:155], v[48:51]
    ds_read_b64_tr_b16 v[216:217], v15 offset:12288
    ds_read_b64_tr_b16 v[218:219], v15 offset:13056
    v_mfma_f32_16x16x32_bf16 v[72:75], v[208:211], v[156:159], v[72:75]
    s_add_u32 s67, s67, 1
    s_and_b32 s67, s67, 15
    v_mfma_f32_16x16x32_bf16 v[96:99], v[208:211], v[160:163], v[96:99]
    s_mul_i32 s12, s67, 88064
    v_mfma_f32_16x16x32_bf16 v[120:123], v[208:211], v[164:167], v[120:123]
    s_waitcnt lgkmcnt(2)
    v_mfma_f32_16x16x32_bf16 v[52:55], v[212:215], v[152:155], v[52:55]
    ds_read_b64_tr_b16 v[220:221], v15 offset:18432
    ds_read_b64_tr_b16 v[222:223], v15 offset:19200
    v_mfma_f32_16x16x32_bf16 v[76:79], v[212:215], v[156:159], v[76:79]
    v_mfma_f32_16x16x32_bf16 v[100:103], v[212:215], v[160:163], v[100:103]
    v_mfma_f32_16x16x32_bf16 v[124:127], v[212:215], v[164:167], v[124:127]
    s_waitcnt vmcnt(10) lgkmcnt(0)
    s_barrier
    v_mfma_f32_16x16x32_bf16 v[56:59], v[216:219], v[152:155], v[56:59]
    ds_read_b128 v[168:171], v9 offset:16384
    ds_read_b128 v[172:175], v9 offset:18432
    v_mfma_f32_16x16x32_bf16 v[80:83], v[216:219], v[156:159], v[80:83]
    ds_read_b128 v[176:179], v10 offset:16384
    ds_read_b128 v[180:183], v10 offset:18432
    v_mfma_f32_16x16x32_bf16 v[104:107], v[216:219], v[160:163], v[104:107]
    ds_read_b64_tr_b16 v[200:201], v13 offset:24576
    ds_read_b64_tr_b16 v[202:203], v13 offset:25344
    v_mfma_f32_16x16x32_bf16 v[128:131], v[216:219], v[164:167], v[128:131]
    ds_read_b64_tr_b16 v[204:205], v13 offset:30720
    ds_read_b64_tr_b16 v[206:207], v13 offset:31488
    v_mfma_f32_16x16x32_bf16 v[60:63], v[220:223], v[152:155], v[60:63]
    v_mfma_f32_16x16x32_bf16 v[84:87], v[220:223], v[156:159], v[84:87]
    v_mfma_f32_16x16x32_bf16 v[108:111], v[220:223], v[160:163], v[108:111]
    v_mfma_f32_16x16x32_bf16 v[132:135], v[220:223], v[164:167], v[132:135]
    s_waitcnt lgkmcnt(2)
    v_mfma_f32_16x16x32_bf16 v[40:43], v[200:203], v[168:171], v[40:43]
    s_add_u32 m0, s10, 12288
    ds_read_b128 v[184:187], v11 offset:16384
    v_mfma_f32_16x16x32_bf16 v[64:67], v[200:203], v[172:175], v[64:67]
    ds_read_b128 v[188:191], v11 offset:18432
    ds_read_b64_tr_b16 v[208:209], v14 offset:24576
    v_mfma_f32_16x16x32_bf16 v[88:91], v[200:203], v[176:179], v[88:91]
    ds_read_b64_tr_b16 v[210:211], v14 offset:25344
    buffer_load_dwordx4 v6, s[52:55], s12 offen offset:0 lds
    v_mfma_f32_16x16x32_bf16 v[112:115], v[200:203], v[180:183], v[112:115]
    s_waitcnt lgkmcnt(2)
    v_mfma_f32_16x16x32_bf16 v[44:47], v[204:207], v[168:171], v[44:47]
    ds_read_b128 v[192:195], v12 offset:16384
    ds_read_b128 v[196:199], v12 offset:18432
    v_mfma_f32_16x16x32_bf16 v[68:71], v[204:207], v[172:175], v[68:71]
    ds_read_b64_tr_b16 v[212:213], v14 offset:30720
    ds_read_b64_tr_b16 v[214:215], v14 offset:31488
    v_mfma_f32_16x16x32_bf16 v[92:95], v[204:207], v[176:179], v[92:95]
    buffer_load_dwordx4 v7, s[52:55], s12 offen offset:1024 lds
    buffer_load_dwordx4 v8, s[52:55], s12 offen offset:2048 lds
    v_mfma_f32_16x16x32_bf16 v[116:119], v[204:207], v[180:183], v[116:119]
    s_waitcnt lgkmcnt(2)
    v_mfma_f32_16x16x32_bf16 v[48:51], v[208:211], v[168:171], v[48:51]
    ds_read_b64_tr_b16 v[216:217], v15 offset:24576
    ds_read_b64_tr_b16 v[218:219], v15 offset:25344
    v_mfma_f32_16x16x32_bf16 v[72:75], v[208:211], v[172:175], v[72:75]
    s_add_u32 s67, s67, 1
    s_and_b32 s67, s67, 15
    v_mfma_f32_16x16x32_bf16 v[96:99], v[208:211], v[176:179], v[96:99]
    s_mul_i32 s12, s67, 88064
    v_mfma_f32_16x16x32_bf16 v[120:123], v[208:211], v[180:183], v[120:123]
    s_waitcnt lgkmcnt(2)
    v_mfma_f32_16x16x32_bf16 v[52:55], v[212:215], v[168:171], v[52:55]
    ds_read_b64_tr_b16 v[220:221], v15 offset:30720
    ds_read_b64_tr_b16 v[222:223], v15 offset:31488
    v_mfma_f32_16x16x32_bf16 v[76:79], v[212:215], v[172:175], v[76:79]
    v_mfma_f32_16x16x32_bf16 v[100:103], v[212:215], v[176:179], v[100:103]
    v_mfma_f32_16x16x32_bf16 v[124:127], v[212:215], v[180:183], v[124:127]
    s_waitcnt vmcnt(10) lgkmcnt(0)
    s_barrier
    v_mfma_f32_16x16x32_bf16 v[56:59], v[216:219], v[168:171], v[56:59]
    s_add_u32 m0, s9, 16384
    ds_read_b64_tr_b16 v[200:201], v13 offset:36864
    v_mfma_f32_16x16x32_bf16 v[80:83], v[216:219], v[172:175], v[80:83]
    buffer_load_dwordx4 v2, s[48:51], s11 offen offset:0 lds
    ds_read_b64_tr_b16 v[202:203], v13 offset:37632
    v_mfma_f32_16x16x32_bf16 v[104:107], v[216:219], v[176:179], v[104:107]
    buffer_load_dwordx4 v3, s[48:51], s11 offen offset:1024 lds
    ds_read_b64_tr_b16 v[204:205], v13 offset:43008
    v_mfma_f32_16x16x32_bf16 v[128:131], v[216:219], v[180:183], v[128:131]
    buffer_load_dwordx4 v4, s[48:51], s11 offen offset:2048 lds
    ds_read_b64_tr_b16 v[206:207], v13 offset:43776
    v_mfma_f32_16x16x32_bf16 v[60:63], v[220:223], v[168:171], v[60:63]
    buffer_load_dwordx4 v5, s[48:51], s11 offen offset:3072 lds
    s_add_u32 s11, s11, 128
    v_mfma_f32_16x16x32_bf16 v[84:87], v[220:223], v[172:175], v[84:87]
    s_and_b32 s11, s11, 1023
    v_mfma_f32_16x16x32_bf16 v[108:111], v[220:223], v[176:179], v[108:111]
    v_mfma_f32_16x16x32_bf16 v[132:135], v[220:223], v[180:183], v[132:135]
    s_waitcnt lgkmcnt(2)
    v_mfma_f32_16x16x32_bf16 v[40:43], v[200:203], v[184:187], v[40:43]
    s_add_u32 m0, s10, 24576
    ds_read_b64_tr_b16 v[208:209], v14 offset:36864
    v_mfma_f32_16x16x32_bf16 v[64:67], v[200:203], v[188:191], v[64:67]
    ds_read_b64_tr_b16 v[210:211], v14 offset:37632
    buffer_load_dwordx4 v6, s[52:55], s12 offen offset:0 lds
    v_mfma_f32_16x16x32_bf16 v[88:91], v[200:203], v[192:195], v[88:91]
    v_mfma_f32_16x16x32_bf16 v[112:115], v[200:203], v[196:199], v[112:115]
    s_waitcnt lgkmcnt(2)
    v_mfma_f32_16x16x32_bf16 v[44:47], v[204:207], v[184:187], v[44:47]
    ds_read_b64_tr_b16 v[212:213], v14 offset:43008
    ds_read_b64_tr_b16 v[214:215], v14 offset:43776
    v_mfma_f32_16x16x32_bf16 v[68:71], v[204:207], v[188:191], v[68:71]
    buffer_load_dwordx4 v7, s[52:55], s12 offen offset:1024 lds
    buffer_load_dwordx4 v8, s[52:55], s12 offen offset:2048 lds
    v_mfma_f32_16x16x32_bf16 v[92:95], v[204:207], v[192:195], v[92:95]
    v_mfma_f32_16x16x32_bf16 v[116:119], v[204:207], v[196:199], v[116:119]
    s_waitcnt lgkmcnt(2)
    v_mfma_f32_16x16x32_bf16 v[48:51], v[208:211], v[184:187], v[48:51]
    ds_read_b64_tr_b16 v[216:217], v15 offset:36864
    ds_read_b64_tr_b16 v[218:219], v15 offset:37632
    v_mfma_f32_16x16x32_bf16 v[72:75], v[208:211], v[188:191], v[72:75]
    s_add_u32 s67, s67, 1
    s_and_b32 s67, s67, 15
    v_mfma_f32_16x16x32_bf16 v[96:99], v[208:211], v[192:195], v[96:99]
    s_mul_i32 s12, s67, 88064
    v_mfma_f32_16x16x32_bf16 v[120:123], v[208:211], v[196:199], v[120:123]
    s_waitcnt lgkmcnt(2)
    v_mfma_f32_16x16x32_bf16 v[52:55], v[212:215], v[184:187], v[52:55]
    ds_read_b64_tr_b16 v[220:221], v15 offset:43008
    ds_read_b64_tr_b16 v[222:223], v15 offset:43776
    v_mfma_f32_16x16x32_bf16 v[76:79], v[212:215], v[188:191], v[76:79]
    v_mfma_f32_16x16x32_bf16 v[100:103], v[212:215], v[192:195], v[100:103]
    v_mfma_f32_16x16x32_bf16 v[124:127], v[212:215], v[196:199], v[124:127]
    s_waitcnt vmcnt(10) lgkmcnt(0)
    s_barrier
    v_mfma_f32_16x16x32_bf16 v[56:59], v[216:219], v[184:187], v[56:59]
    ds_read_b128 v[136:139], v9 offset:0
    ds_read_b128 v[140:143], v9 offset:2048
    v_mfma_f32_16x16x32_bf16 v[80:83], v[216:219], v[188:191], v[80:83]
    ds_read_b128 v[144:147], v10 offset:0
    ds_read_b128 v[148:151], v10 offset:2048
    v_mfma_f32_16x16x32_bf16 v[104:107], v[216:219], v[192:195], v[104:107]
    ds_read_b64_tr_b16 v[200:201], v13 offset:0
    ds_read_b64_tr_b16 v[202:203], v13 offset:768
    v_mfma_f32_16x16x32_bf16 v[128:131], v[216:219], v[196:199], v[128:131]
    ds_read_b64_tr_b16 v[204:205], v13 offset:6144
    ds_read_b64_tr_b16 v[206:207], v13 offset:6912
    v_mfma_f32_16x16x32_bf16 v[60:63], v[220:223], v[184:187], v[60:63]
    v_mfma_f32_16x16x32_bf16 v[84:87], v[220:223], v[188:191], v[84:87]
    v_mfma_f32_16x16x32_bf16 v[108:111], v[220:223], v[192:195], v[108:111]
    v_mfma_f32_16x16x32_bf16 v[132:135], v[220:223], v[196:199], v[132:135]
    s_waitcnt lgkmcnt(2)
    v_mfma_f32_16x16x32_bf16 v[40:43], v[200:203], v[136:139], v[40:43]
    s_add_u32 m0, s10, 36864
    ds_read_b128 v[152:155], v11 offset:0
    v_mfma_f32_16x16x32_bf16 v[64:67], v[200:203], v[140:143], v[64:67]
    ds_read_b128 v[156:159], v11 offset:2048
    ds_read_b64_tr_b16 v[208:209], v14 offset:0
    v_mfma_f32_16x16x32_bf16 v[88:91], v[200:203], v[144:147], v[88:91]
    ds_read_b64_tr_b16 v[210:211], v14 offset:768
    buffer_load_dwordx4 v6, s[52:55], s12 offen offset:0 lds
    v_mfma_f32_16x16x32_bf16 v[112:115], v[200:203], v[148:151], v[112:115]
    s_waitcnt lgkmcnt(2)
    v_mfma_f32_16x16x32_bf16 v[44:47], v[204:207], v[136:139], v[44:47]
    ds_read_b128 v[160:163], v12 offset:0
    ds_read_b128 v[164:167], v12 offset:2048
    v_mfma_f32_16x16x32_bf16 v[68:71], v[204:207], v[140:143], v[68:71]
    ds_read_b64_tr_b16 v[212:213], v14 offset:6144
    ds_read_b64_tr_b16 v[214:215], v14 offset:6912
    v_mfma_f32_16x16x32_bf16 v[92:95], v[204:207], v[144:147], v[92:95]
    buffer_load_dwordx4 v7, s[52:55], s12 offen offset:1024 lds
    buffer_load_dwordx4 v8, s[52:55], s12 offen offset:2048 lds
    v_mfma_f32_16x16x32_bf16 v[116:119], v[204:207], v[148:151], v[116:119]
    s_waitcnt lgkmcnt(2)
    v_mfma_f32_16x16x32_bf16 v[48:51], v[208:211], v[136:139], v[48:51]
    ds_read_b64_tr_b16 v[216:217], v15 offset:0
    ds_read_b64_tr_b16 v[218:219], v15 offset:768
    v_mfma_f32_16x16x32_bf16 v[72:75], v[208:211], v[140:143], v[72:75]
    s_add_u32 s67, s67, 1
    s_and_b32 s67, s67, 15
    v_mfma_f32_16x16x32_bf16 v[96:99], v[208:211], v[144:147], v[96:99]
    s_mul_i32 s12, s67, 88064
    v_mfma_f32_16x16x32_bf16 v[120:123], v[208:211], v[148:151], v[120:123]
    s_waitcnt lgkmcnt(2)
    v_mfma_f32_16x16x32_bf16 v[52:55], v[212:215], v[136:139], v[52:55]
    ds_read_b64_tr_b16 v[220:221], v15 offset:6144
    ds_read_b64_tr_b16 v[222:223], v15 offset:6912
    v_mfma_f32_16x16x32_bf16 v[76:79], v[212:215], v[140:143], v[76:79]
    v_mfma_f32_16x16x32_bf16 v[100:103], v[212:215], v[144:147], v[100:103]
    v_mfma_f32_16x16x32_bf16 v[124:127], v[212:215], v[148:151], v[124:127]
    s_sub_u32 s13, s13, 1
    s_cmp_lg_u32 s13, 0
    s_cbranch_scc1 L_g1loop
    s_waitcnt vmcnt(10) lgkmcnt(0)
    s_barrier
    v_mfma_f32_16x16x32_bf16 v[56:59], v[216:219], v[136:139], v[56:59]
    ds_read_b64_tr_b16 v[200:201], v13 offset:12288
    ds_read_b64_tr_b16 v[202:203], v13 offset:13056
    v_mfma_f32_16x16x32_bf16 v[80:83], v[216:219], v[140:143], v[80:83]
    ds_read_b64_tr_b16 v[204:205], v13 offset:18432
    ds_read_b64_tr_b16 v[206:207], v13 offset:19200
    v_mfma_f32_16x16x32_bf16 v[104:107], v[216:219], v[144:147], v[104:107]
    v_mfma_f32_16x16x32_bf16 v[128:131], v[216:219], v[148:151], v[128:131]
    v_mfma_f32_16x16x32_bf16 v[60:63], v[220:223], v[136:139], v[60:63]
    v_mfma_f32_16x16x32_bf16 v[84:87], v[220:223], v[140:143], v[84:87]
    v_mfma_f32_16x16x32_bf16 v[108:111], v[220:223], v[144:147], v[108:111]
    v_mfma_f32_16x16x32_bf16 v[132:135], v[220:223], v[148:151], v[132:135]
    s_cmp_lg_u32 s6, 0
    s_cbranch_scc1 L_g1nq
    global_load_dword v28, v32, s[44:45] sc1
    global_load_dword v27, v26, s[90:91] sc1
L_g1nq:
    s_waitcnt lgkmcnt(2)
    v_mfma_f32_16x16x32_bf16 v[40:43], v[200:203], v[152:155], v[40:43]
    ds_read_b64_tr_b16 v[208:209], v14 offset:12288
    ds_read_b64_tr_b16 v[210:211], v14 offset:13056
    v_mfma_f32_16x16x32_bf16 v[64:67], v[200:203], v[156:159], v[64:67]
    v_mfma_f32_16x16x32_bf16 v[88:91], v[200:203], v[160:163], v[88:91]
    v_mfma_f32_16x16x32_bf16 v[112:115], v[200:203], v[164:167], v[112:115]
    s_waitcnt lgkmcnt(2)
    v_mfma_f32_16x16x32_bf16 v[44:47], v[204:207], v[152:155], v[44:47]
    ds_read_b64_tr_b16 v[212:213], v14 offset:18432
    ds_read_b64_tr_b16 v[214:215], v14 offset:19200
    v_mfma_f32_16x16x32_bf16 v[68:71], v[204:207], v[156:159], v[68:71]
    v_mfma_f32_16x16x32_bf16 v[92:95], v[204:207], v[160:163], v[92:95]
    v_mfma_f32_16x16x32_bf16 v[116:119], v[204:207], v[164:167], v[116:119]
    s_waitcnt lgkmcnt(2)
    v_mfma_f32_16x16x32_bf16 v[48:51], v[208:211], v[152:155], v[48:51]
    ds_read_b64_tr_b16 v[216:217], v15 offset:12288
    ds_read_b64_tr_b16 v[218:219], v15 offset:13056
    v_mfma_f32_16x16x32_bf16 v[72:75], v[208:211], v[156:159], v[72:75]
    v_mfma_f32_16x16x32_bf16 v[96:99], v[208:211], v[160:163], v[96:99]
    v_mfma_f32_16x16x32_bf16 v[120:123], v[208:211], v[164:167], v[120:123]
    s_waitcnt lgkmcnt(2)
    v_mfma_f32_16x16x32_bf16 v[52:55], v[212:215], v[152:155], v[52:55]
    ds_read_b64_tr_b16 v[220:221], v15 offset:18432
    ds_read_b64_tr_b16 v[222:223], v15 offset:19200
    v_mfma_f32_16x16x32_bf16 v[76:79], v[212:215], v[156:159], v[76:79]
    v_mfma_f32_16x16x32_bf16 v[100:103], v[212:215], v[160:163], v[100:103]
    v_mfma_f32_16x16x32_bf16 v[124:127], v[212:215], v[164:167], v[124:127]
    s_waitcnt vmcnt(0) lgkmcnt(0)
    s_cmp_lg_u32 s6, 0
    s_cbranch_scc1 L_g1np
    s_mov_b32 s94, 0
L_g1_p:
    s_waitcnt vmcnt(0)
    v_cmp_ne_u32 vcc, v27, v28
    v_cmp_eq_u32 s[92:93], 0, v28
    s_add_u32 s94, s94, 1
    s_cmp_gt_u32 s94, 0x200000
    s_cbranch_scc1 L_g1_d
    s_or_b64 vcc, vcc, s[92:93]
    s_cbranch_vccz L_g1_d
    s_sleep 4
    global_load_dword v28, v32, s[44:45] sc1
    global_load_dword v27, v26, s[90:91] sc1
    s_branch L_g1_p
L_g1_d:
L_g1np:
    s_barrier
    v_mfma_f32_16x16x32_bf16 v[56:59], v[216:219], v[152:155], v[56:59]
    ds_read_b128 v[168:171], v9 offset:16384
    ds_read_b128 v[172:175], v9 offset:18432
    v_mfma_f32_16x16x32_bf16 v[80:83], v[216:219], v[156:159], v[80:83]
    ds_read_b128 v[176:179], v10 offset:16384
    ds_read_b128 v[180:183], v10 offset:18432
    v_mfma_f32_16x16x32_bf16 v[104:107], v[216:219], v[160:163], v[104:107]
    ds_read_b64_tr_b16 v[200:201], v13 offset:24576
    ds_read_b64_tr_b16 v[202:203], v13 offset:25344
    v_mfma_f32_16x16x32_bf16 v[128:131], v[216:219], v[164:167], v[128:131]
    ds_read_b64_tr_b16 v[204:205], v13 offset:30720
    ds_read_b64_tr_b16 v[206:207], v13 offset:31488
    v_mfma_f32_16x16x32_bf16 v[60:63], v[220:223], v[152:155], v[60:63]
    v_mfma_f32_16x16x32_bf16 v[84:87], v[220:223], v[156:159], v[84:87]
    v_mfma_f32_16x16x32_bf16 v[108:111], v[220:223], v[160:163], v[108:111]
    v_mfma_f32_16x16x32_bf16 v[132:135], v[220:223], v[164:167], v[132:135]
    s_waitcnt lgkmcnt(2)
    v_mfma_f32_16x16x32_bf16 v[40:43], v[200:203], v[168:171], v[40:43]
    ds_read_b128 v[184:187], v11 offset:16384
    ds_read_b128 v[188:191], v11 offset:18432
    v_mfma_f32_16x16x32_bf16 v[64:67], v[200:203], v[172:175], v[64:67]
    ds_read_b64_tr_b16 v[208:209], v14 offset:24576
    ds_read_b64_tr_b16 v[210:211], v14 offset:25344
    v_mfma_f32_16x16x32_bf16 v[88:91], v[200:203], v[176:179], v[88:91]
    v_mfma_f32_16x16x32_bf16 v[112:115], v[200:203], v[180:183], v[112:115]
    s_waitcnt lgkmcnt(2)
    v_mfma_f32_16x16x32_bf16 v[44:47], v[204:207], v[168:171], v[44:47]
    ds_read_b128 v[192:195], v12 offset:16384
    ds_read_b128 v[196:199], v12 offset:18432
    v_mfma_f32_16x16x32_bf16 v[68:71], v[204:207], v[172:175], v[68:71]
    ds_read_b64_tr_b16 v[212:213], v14 offset:30720
    ds_read_b64_tr_b16 v[214:215], v14 offset:31488
    v_mfma_f32_16x16x32_bf16 v[92:95], v[204:207], v[176:179], v[92:95]
    v_mfma_f32_16x16x32_bf16 v[116:119], v[204:207], v[180:183], v[116:119]
    s_waitcnt lgkmcnt(2)
    v_mfma_f32_16x16x32_bf16 v[48:51], v[208:211], v[168:171], v[48:51]
    ds_read_b64_tr_b16 v[216:217], v15 offset:24576
    ds_read_b64_tr_b16 v[218:219], v15 offset:25344
    v_mfma_f32_16x16x32_bf16 v[72:75], v[208:211], v[172:175], v[72:75]
    global_load_dwordx4 v[136:139], v29, s[60:61] offset:0 sc1
    global_load_dwordx4 v[140:143], v29, s[60:61] offset:256 sc1
    v_mfma_f32_16x16x32_bf16 v[96:99], v[208:211], v[176:179], v[96:99]
    global_load_dwordx4 v[144:147], v30, s[60:61] offset:0 sc1
    global_load_dwordx4 v[148:151], v30, s[60:61] offset:256 sc1
    v_mfma_f32_16x16x32_bf16 v[120:123], v[208:211], v[180:183], v[120:123]
    global_load_dwordx4 v[152:155], v31, s[62:63] offset:0 sc1
    s_waitcnt lgkmcnt(2)
    v_mfma_f32_16x16x32_bf16 v[52:55], v[212:215], v[168:171], v[52:55]
    ds_read_b64_tr_b16 v[220:221], v15 offset:30720
    ds_read_b64_tr_b16 v[222:223], v15 offset:31488
    v_mfma_f32_16x16x32_bf16 v[76:79], v[212:215], v[172:175], v[76:79]
    global_load_dwordx4 v[156:159], v31, s[62:63] offset:64 sc1
    global_load_dwordx4 v[160:163], v31, s[62:63] offset:128 sc1
    v_mfma_f32_16x16x32_bf16 v[100:103], v[212:215], v[176:179], v[100:103]
    global_load_dwordx4 v[164:167], v31, s[62:63] offset:192 sc1
    global_load_dwordx4 v[224:227], v31, s[62:63] offset:256 sc1
    v_mfma_f32_16x16x32_bf16 v[124:127], v[212:215], v[180:183], v[124:127]
    global_load_dwordx4 v[228:231], v31, s[62:63] offset:320 sc1
    s_waitcnt lgkmcnt(0)
    s_barrier
    v_mfma_f32_16x16x32_bf16 v[56:59], v[216:219], v[168:171], v[56:59]
    ds_read_b64_tr_b16 v[200:201], v13 offset:36864
    ds_read_b64_tr_b16 v[202:203], v13 offset:37632
    v_mfma_f32_16x16x32_bf16 v[80:83], v[216:219], v[172:175], v[80:83]
    ds_read_b64_tr_b16 v[204:205], v13 offset:43008
    ds_read_b64_tr_b16 v[206:207], v13 offset:43776
    v_mfma_f32_16x16x32_bf16 v[104:107], v[216:219], v[176:179], v[104:107]
    v_mfma_f32_16x16x32_bf16 v[128:131], v[216:219], v[180:183], v[128:131]
    v_mfma_f32_16x16x32_bf16 v[60:63], v[220:223], v[168:171], v[60:63]
    v_mfma_f32_16x16x32_bf16 v[84:87], v[220:223], v[172:175], v[84:87]
    v_mfma_f32_16x16x32_bf16 v[108:111], v[220:223], v[176:179], v[108:111]
    v_mfma_f32_16x16x32_bf16 v[132:135], v[220:223], v[180:183], v[132:135]
    s_waitcnt lgkmcnt(2)
    v_mfma_f32_16x16x32_bf16 v[40:43], v[200:203], v[184:187], v[40:43]
    ds_read_b64_tr_b16 v[208:209], v14 offset:36864
    ds_read_b64_tr_b16 v[210:211], v14 offset:37632
    v_mfma_f32_16x16x32_bf16 v[64:67], v[200:203], v[188:191], v[64:67]
    v_mfma_f32_16x16x32_bf16 v[88:91], v[200:203], v[192:195], v[88:91]
    v_mfma_f32_16x16x32_bf16 v[112:115], v[200:203], v[196:199], v[112:115]
    s_waitcnt lgkmcnt(2)
    v_mfma_f32_16x16x32_bf16 v[44:47], v[204:207], v[184:187], v[44:47]
    ds_read_b64_tr_b16 v[212:213], v14 offset:43008
    ds_read_b64_tr_b16 v[214:215], v14 offset:43776
    v_mfma_f32_16x16x32_bf16 v[68:71], v[204:207], v[188:191], v[68:71]
    v_mfma_f32_16x16x32_bf16 v[92:95], v[204:207], v[192:195], v[92:95]
    v_mfma_f32_16x16x32_bf16 v[116:119], v[204:207], v[196:199], v[116:119]
    s_waitcnt lgkmcnt(2)
    v_mfma_f32_16x16x32_bf16 v[48:51], v[208:211], v[184:187], v[48:51]
    ds_read_b64_tr_b16 v[216:217], v15 offset:36864
    ds_read_b64_tr_b16 v[218:219], v15 offset:37632
    v_mfma_f32_16x16x32_bf16 v[72:75], v[208:211], v[188:191], v[72:75]
    v_mfma_f32_16x16x32_bf16 v[96:99], v[208:211], v[192:195], v[96:99]
    v_mfma_f32_16x16x32_bf16 v[120:123], v[208:211], v[196:199], v[120:123]
    s_waitcnt lgkmcnt(2)
    v_mfma_f32_16x16x32_bf16 v[52:55], v[212:215], v[184:187], v[52:55]
    ds_read_b64_tr_b16 v[220:221], v15 offset:43008
    ds_read_b64_tr_b16 v[222:223], v15 offset:43776
    v_mfma_f32_16x16x32_bf16 v[76:79], v[212:215], v[188:191], v[76:79]
    v_mfma_f32_16x16x32_bf16 v[100:103], v[212:215], v[192:195], v[100:103]
    v_mfma_f32_16x16x32_bf16 v[124:127], v[212:215], v[196:199], v[124:127]
    s_waitcnt lgkmcnt(0)
    v_mfma_f32_16x16x32_bf16 v[56:59], v[216:219], v[184:187], v[56:59]
    s_mov_b32 s56, s46
    s_mov_b32 s57, s47
    s_mov_b32 s58, 5636096
    s_mov_b32 s59, 0x00020000
    v_mfma_f32_16x16x32_bf16 v[80:83], v[216:219], v[188:191], v[80:83]
    s_lshl_b32 s3, s4, 3
    s_lshl_b32 s14, s7, 2
    s_add_u32 s3, s3, s14
    s_lshl_b32 s15, s8, 1
    v_mfma_f32_16x16x32_bf16 v[104:107], v[216:219], v[192:195], v[104:107]
    s_mul_i32 s66, s5, 3
    s_add_u32 s60, s3, s15
    s_mul_i32 s60, s60, 43
    s_add_u32 s60, s60, s66
    v_mfma_f32_16x16x32_bf16 v[128:131], v[216:219], v[196:199], v[128:131]
    s_lshl_b32 s60, s60, 10
    s_xor_b32 s61, s15, 2
    s_add_u32 s61, s61, s3
    s_mul_i32 s61, s61, 43
    v_mfma_f32_16x16x32_bf16 v[60:63], v[220:223], v[184:187], v[60:63]
    s_add_u32 s61, s61, s66
    s_lshl_b32 s61, s61, 10
    s_add_u32 s62, s60, 44032
    s_add_u32 s63, s61, 44032
    v_mfma_f32_16x16x32_bf16 v[84:87], v[220:223], v[188:191], v[84:87]
    s_lshl_b32 s3, s8, 11
    v_lshl_add_u32 v9, v1, 4, s3
    s_lshl_b32 s3, s8, 3
    s_add_u32 s3, s3, 1024
    v_mfma_f32_16x16x32_bf16 v[108:111], v[220:223], v[192:195], v[108:111]
    v_lshl_add_u32 v10, v1, 4, s3
    v_mfma_f32_16x16x32_bf16 v[132:135], v[220:223], v[196:199], v[132:135]
    s_waitcnt vmcnt(0)
    s_barrier
    s_and_b32 s100, s2, 1
    s_lshl_b32 s101, s100, 9
    s_lshr_b32 s3, s2, 6
    s_lshl_b32 s3, s3, 7
    s_add_u32 s3, s3, s101
    v_lshrrev_b32 v232, 3, v1
    v_and_b32 v233, 6, v232
    v_and_b32 v234, 7, v1
    v_xor_b32 v233, v233, v234
    v_lshlrev_b32 v232, 10, v232
    v_lshl_add_u32 v232, v233, 4, v232
    v_add_u32 v232, s3, v232
    v_add_u32 v233, 7168, v232
    v_add_u32 v234, 14336, v232
    v_add_u32 v235, 21504, v232
    s_mul_i32 s101, s100, 24
    s_add_u32 s101, s101, s6
    s_lshl_b32 s101, s101, 15
    s_lshl_b32 s100, s6, 14
    s_mov_b32 s96, s40
    s_mov_b32 s97, s41
    s_mov_b32 s98, 1409024
    s_mov_b32 s99, 0x00020000
    s_add_u32 m0, s100, 0
    s_nop 0
    buffer_load_dwordx4 v232, s[96:99], s101 offen offset:0 lds
    buffer_load_dwordx4 v233, s[96:99], s101 offen offset:1024 lds
    buffer_load_dwordx4 v234, s[96:99], s101 offen offset:2048 lds
    buffer_load_dwordx4 v235, s[96:99], s101 offen offset:3072 lds
    s_add_u32 s101, s101, 0x20000
    s_add_u32 m0, s100, 4096
    s_nop 0
    buffer_load_dwordx4 v232, s[96:99], s101 offen offset:0 lds
    buffer_load_dwordx4 v233, s[96:99], s101 offen offset:1024 lds
    buffer_load_dwordx4 v234, s[96:99], s101 offen offset:2048 lds
    buffer_load_dwordx4 v235, s[96:99], s101 offen offset:3072 lds
    s_add_u32 s101, s101, 0x20000
    s_add_u32 m0, s100, 8192
    s_nop 0
    buffer_load_dwordx4 v232, s[96:99], s101 offen offset:0 lds
    buffer_load_dwordx4 v233, s[96:99], s101 offen offset:1024 lds
    buffer_load_dwordx4 v234, s[96:99], s101 offen offset:2048 lds
    buffer_load_dwordx4 v235, s[96:99], s101 offen offset:3072 lds
    s_add_u32 s101, s101, 0x20000
    s_add_u32 m0, s100, 12288
    s_nop 0
    buffer_load_dwordx4 v232, s[96:99], s101 offen offset:0 lds
    buffer_load_dwordx4 v233, s[96:99], s101 offen offset:1024 lds
    buffer_load_dwordx4 v234, s[96:99], s101 offen offset:2048 lds
    buffer_load_dwordx4 v235, s[96:99], s101 offen offset:3072 lds
    s_add_u32 s101, s101, 0x20000
    s_cmp_eq_u32 s5, 14
    s_cselect_b32 s3, 1, 0
    s_and_b32 s14, s3, s8
    s_cmp_lg_u32 s14, 0
    s_cbranch_scc1 L_g1skw
    v_fma_f32 v40, v152, v136, v40
    v_fma_f32 v41, v153, v136, v41
    v_fma_f32 v42, v154, v136, v42
    v_fma_f32 v43, v155, v136, v43
    v_fma_f32 v48, v160, v136, v48
    v_fma_f32 v49, v161, v136, v49
    v_fma_f32 v50, v162, v136, v50
    v_fma_f32 v51, v163, v136, v51
    v_fma_f32 v64, v152, v140, v64
    v_fma_f32 v65, v153, v140, v65
    v_fma_f32 v66, v154, v140, v66
    v_fma_f32 v67, v155, v140, v67
    v_fma_f32 v72, v160, v140, v72
    v_fma_f32 v73, v161, v140, v73
    v_fma_f32 v74, v162, v140, v74
    v_fma_f32 v75, v163, v140, v75
    v_fma_f32 v168, v40, v137, v139
    v_fma_f32 v169, v41, v137, v139
    v_fma_f32 v170, v42, v137, v139
    v_fma_f32 v171, v43, v137, v139
    v_fma_f32 v172, v48, v137, v139
    v_fma_f32 v173, v49, v137, v139
    v_fma_f32 v174, v50, v137, v139
    v_fma_f32 v175, v51, v137, v139
    v_fma_f32 v176, v64, v141, v143
    v_fma_f32 v177, v65, v141, v143
    v_fma_f32 v178, v66, v141, v143
    v_fma_f32 v179, v67, v141, v143
    v_fma_f32 v180, v72, v141, v143
    v_fma_f32 v181, v73, v141, v143
    v_fma_f32 v182, v74, v141, v143
    v_fma_f32 v183, v75, v141, v143
    v_fma_f32 v44, v156, v136, v44
    v_fma_f32 v45, v157, v136, v45
    v_fma_f32 v46, v158, v136, v46
    v_fma_f32 v47, v159, v136, v47
    v_exp_f32 v168, v168
    v_exp_f32 v169, v169
    v_exp_f32 v170, v170
    v_exp_f32 v171, v171
    v_fma_f32 v52, v164, v136, v52
    v_fma_f32 v53, v165, v136, v53
    v_fma_f32 v54, v166, v136, v54
    v_fma_f32 v55, v167, v136, v55
    v_exp_f32 v172, v172
    v_exp_f32 v173, v173
    v_exp_f32 v174, v174
    v_exp_f32 v175, v175
    v_fma_f32 v68, v156, v140, v68
    v_fma_f32 v69, v157, v140, v69
    v_fma_f32 v70, v158, v140, v70
    v_fma_f32 v71, v159, v140, v71
    v_exp_f32 v176, v176
    v_exp_f32 v177, v177
    v_exp_f32 v178, v178
    v_exp_f32 v179, v179
    v_fma_f32 v76, v164, v140, v76
    v_fma_f32 v77, v165, v140, v77
    v_fma_f32 v78, v166, v140, v78
    v_fma_f32 v79, v167, v140, v79
    v_exp_f32 v180, v180
    v_exp_f32 v181, v181
    v_exp_f32 v182, v182
    v_exp_f32 v183, v183
    v_mul_f32 v40, v40, v44
    v_mul_f32 v41, v41, v45
    v_mul_f32 v42, v42, v46
    v_mul_f32 v43, v43, v47
    v_mul_f32 v48, v48, v52
    v_mul_f32 v49, v49, v53
    v_mul_f32 v50, v50, v54
    v_mul_f32 v51, v51, v55
    v_mul_f32 v64, v64, v68
    v_mul_f32 v65, v65, v69
    v_mul_f32 v66, v66, v70
    v_mul_f32 v67, v67, v71
    v_mul_f32 v72, v72, v76
    v_mul_f32 v73, v73, v77
    v_mul_f32 v74, v74, v78
    v_mul_f32 v75, v75, v79
    v_add_f32 v168, v168, v138
    v_add_f32 v169, v169, v138
    v_add_f32 v170, v170, v138
    v_add_f32 v171, v171, v138
    v_add_f32 v172, v172, v138
    v_add_f32 v173, v173, v138
    v_add_f32 v174, v174, v138
    v_add_f32 v175, v175, v138
    v_add_f32 v176, v176, v142
    v_add_f32 v177, v177, v142
    v_add_f32 v178, v178, v142
    v_add_f32 v179, v179, v142
    v_add_f32 v180, v180, v142
    v_add_f32 v181, v181, v142
    v_add_f32 v182, v182, v142
    v_add_f32 v183, v183, v142
    v_rcp_f32 v168, v168
    v_rcp_f32 v169, v169
    v_rcp_f32 v170, v170
    v_rcp_f32 v171, v171
    v_rcp_f32 v172, v172
    v_rcp_f32 v173, v173
    v_rcp_f32 v174, v174
    v_rcp_f32 v175, v175
    v_rcp_f32 v176, v176
    v_rcp_f32 v177, v177
    v_rcp_f32 v178, v178
    v_rcp_f32 v179, v179
    v_rcp_f32 v180, v180
    v_rcp_f32 v181, v181
    v_rcp_f32 v182, v182
    v_rcp_f32 v183, v183
    s_nop 0
    v_mul_f32 v40, v40, v168
    v_mul_f32 v41, v41, v169
    v_mul_f32 v42, v42, v170
    v_mul_f32 v43, v43, v171
    v_mul_f32 v48, v48, v172
    v_mul_f32 v49, v49, v173
    v_mul_f32 v50, v50, v174
    v_mul_f32 v51, v51, v175
    v_mul_f32 v64, v64, v176
    v_mul_f32 v65, v65, v177
    v_mul_f32 v66, v66, v178
    v_mul_f32 v67, v67, v179
    v_mul_f32 v72, v72, v180
    v_mul_f32 v73, v73, v181
    v_mul_f32 v74, v74, v182
    v_mul_f32 v75, v75, v183
    v_cvt_pk_bf16_f32 v168, v40, v41
    v_cvt_pk_bf16_f32 v169, v42, v43
    v_cvt_pk_bf16_f32 v170, v48, v49
    v_cvt_pk_bf16_f32 v171, v50, v51
    buffer_store_dwordx4 v[168:171], v9, s[56:59], s60 offen sc1
    v_cvt_pk_bf16_f32 v176, v64, v65
    v_cvt_pk_bf16_f32 v177, v66, v67
    v_cvt_pk_bf16_f32 v178, v72, v73
    v_cvt_pk_bf16_f32 v179, v74, v75
    buffer_store_dwordx4 v[176:179], v9, s[56:59], s62 offen sc1
    v_fma_f32 v88, v152, v144, v88
    v_fma_f32 v89, v153, v144, v89
    v_fma_f32 v90, v154, v144, v90
    v_fma_f32 v91, v155, v144, v91
    v_fma_f32 v96, v160, v144, v96
    v_fma_f32 v97, v161, v144, v97
    v_fma_f32 v98, v162, v144, v98
    v_fma_f32 v99, v163, v144, v99
    v_fma_f32 v112, v152, v148, v112
    v_fma_f32 v113, v153, v148, v113
    v_fma_f32 v114, v154, v148, v114
    v_fma_f32 v115, v155, v148, v115
    v_fma_f32 v120, v160, v148, v120
    v_fma_f32 v121, v161, v148, v121
    v_fma_f32 v122, v162, v148, v122
    v_fma_f32 v123, v163, v148, v123
    v_fma_f32 v168, v88, v145, v147
    v_fma_f32 v169, v89, v145, v147
    v_fma_f32 v170, v90, v145, v147
    v_fma_f32 v171, v91, v145, v147
    v_fma_f32 v172, v96, v145, v147
    v_fma_f32 v173, v97, v145, v147
    v_fma_f32 v174, v98, v145, v147
    v_fma_f32 v175, v99, v145, v147
    v_fma_f32 v176, v112, v149, v151
    v_fma_f32 v177, v113, v149, v151
    v_fma_f32 v178, v114, v149, v151
    v_fma_f32 v179, v115, v149, v151
    v_fma_f32 v180, v120, v149, v151
    v_fma_f32 v181, v121, v149, v151
    v_fma_f32 v182, v122, v149, v151
    v_fma_f32 v183, v123, v149, v151
    v_fma_f32 v92, v156, v144, v92
    v_fma_f32 v93, v157, v144, v93
    v_fma_f32 v94, v158, v144, v94
    v_fma_f32 v95, v159, v144, v95
    v_exp_f32 v168, v168
    v_exp_f32 v169, v169
    v_exp_f32 v170, v170
    v_exp_f32 v171, v171
    v_fma_f32 v100, v164, v144, v100
    v_fma_f32 v101, v165, v144, v101
    v_fma_f32 v102, v166, v144, v102
    v_fma_f32 v103, v167, v144, v103
    v_exp_f32 v172, v172
    v_exp_f32 v173, v173
    v_exp_f32 v174, v174
    v_exp_f32 v175, v175
    v_fma_f32 v116, v156, v148, v116
    v_fma_f32 v117, v157, v148, v117
    v_fma_f32 v118, v158, v148, v118
    v_fma_f32 v119, v159, v148, v119
    v_exp_f32 v176, v176
    v_exp_f32 v177, v177
    v_exp_f32 v178, v178
    v_exp_f32 v179, v179
    v_fma_f32 v124, v164, v148, v124
    v_fma_f32 v125, v165, v148, v125
    v_fma_f32 v126, v166, v148, v126
    v_fma_f32 v127, v167, v148, v127
    v_exp_f32 v180, v180
    v_exp_f32 v181, v181
    v_exp_f32 v182, v182
    v_exp_f32 v183, v183
    v_mul_f32 v88, v88, v92
    v_mul_f32 v89, v89, v93
    v_mul_f32 v90, v90, v94
    v_mul_f32 v91, v91, v95
    v_mul_f32 v96, v96, v100
    v_mul_f32 v97, v97, v101
    v_mul_f32 v98, v98, v102
    v_mul_f32 v99, v99, v103
    v_mul_f32 v112, v112, v116
    v_mul_f32 v113, v113, v117
    v_mul_f32 v114, v114, v118
    v_mul_f32 v115, v115, v119
    v_mul_f32 v120, v120, v124
    v_mul_f32 v121, v121, v125
    v_mul_f32 v122, v122, v126
    v_mul_f32 v123, v123, v127
    v_add_f32 v168, v168, v146
    v_add_f32 v169, v169, v146
    v_add_f32 v170, v170, v146
    v_add_f32 v171, v171, v146
    v_add_f32 v172, v172, v146
    v_add_f32 v173, v173, v146
    v_add_f32 v174, v174, v146
    v_add_f32 v175, v175, v146
    v_add_f32 v176, v176, v150
    v_add_f32 v177, v177, v150
    v_add_f32 v178, v178, v150
    v_add_f32 v179, v179, v150
    v_add_f32 v180, v180, v150
    v_add_f32 v181, v181, v150
    v_add_f32 v182, v182, v150
    v_add_f32 v183, v183, v150
    v_rcp_f32 v168, v168
    v_rcp_f32 v169, v169
    v_rcp_f32 v170, v170
    v_rcp_f32 v171, v171
    v_rcp_f32 v172, v172
    v_rcp_f32 v173, v173
    v_rcp_f32 v174, v174
    v_rcp_f32 v175, v175
    v_rcp_f32 v176, v176
    v_rcp_f32 v177, v177
    v_rcp_f32 v178, v178
    v_rcp_f32 v179, v179
    v_rcp_f32 v180, v180
    v_rcp_f32 v181, v181
    v_rcp_f32 v182, v182
    v_rcp_f32 v183, v183
    s_nop 0
    v_mul_f32 v88, v88, v168
    v_mul_f32 v89, v89, v169
    v_mul_f32 v90, v90, v170
    v_mul_f32 v91, v91, v171
    v_mul_f32 v96, v96, v172
    v_mul_f32 v97, v97, v173
    v_mul_f32 v98, v98, v174
    v_mul_f32 v99, v99, v175
    v_mul_f32 v112, v112, v176
    v_mul_f32 v113, v113, v177
    v_mul_f32 v114, v114, v178
    v_mul_f32 v115, v115, v179
    v_mul_f32 v120, v120, v180
    v_mul_f32 v121, v121, v181
    v_mul_f32 v122, v122, v182
    v_mul_f32 v123, v123, v183
    v_cvt_pk_bf16_f32 v168, v88, v89
    v_cvt_pk_bf16_f32 v169, v90, v91
    v_cvt_pk_bf16_f32 v170, v96, v97
    v_cvt_pk_bf16_f32 v171, v98, v99
    buffer_store_dwordx4 v[168:171], v9, s[56:59], s61 offen sc1
    v_cvt_pk_bf16_f32 v176, v112, v113
    v_cvt_pk_bf16_f32 v177, v114, v115
    v_cvt_pk_bf16_f32 v178, v120, v121
    v_cvt_pk_bf16_f32 v179, v122, v123
    buffer_store_dwordx4 v[176:179], v9, s[56:59], s63 offen sc1
    s_cmp_lg_u32 s3, 0
    s_cbranch_scc1 L_g1done
    v_fma_f32 v56, v224, v136, v56
    v_fma_f32 v57, v225, v136, v57
    v_fma_f32 v58, v226, v136, v58
    v_fma_f32 v59, v227, v136, v59
    v_fma_f32 v80, v224, v140, v80
    v_fma_f32 v81, v225, v140, v81
    v_fma_f32 v82, v226, v140, v82
    v_fma_f32 v83, v227, v140, v83
    v_fma_f32 v104, v224, v144, v104
    v_fma_f32 v105, v225, v144, v105
    v_fma_f32 v106, v226, v144, v106
    v_fma_f32 v107, v227, v144, v107
    v_fma_f32 v128, v224, v148, v128
    v_fma_f32 v129, v225, v148, v129
    v_fma_f32 v130, v226, v148, v130
    v_fma_f32 v131, v227, v148, v131
    v_fma_f32 v168, v56, v137, v139
    v_fma_f32 v169, v57, v137, v139
    v_fma_f32 v170, v58, v137, v139
    v_fma_f32 v171, v59, v137, v139
    v_fma_f32 v172, v80, v141, v143
    v_fma_f32 v173, v81, v141, v143
    v_fma_f32 v174, v82, v141, v143
    v_fma_f32 v175, v83, v141, v143
    v_fma_f32 v176, v104, v145, v147
    v_fma_f32 v177, v105, v145, v147
    v_fma_f32 v178, v106, v145, v147
    v_fma_f32 v179, v107, v145, v147
    v_fma_f32 v180, v128, v149, v151
    v_fma_f32 v181, v129, v149, v151
    v_fma_f32 v182, v130, v149, v151
    v_fma_f32 v183, v131, v149, v151
    v_fma_f32 v60, v228, v136, v60
    v_fma_f32 v61, v229, v136, v61
    v_fma_f32 v62, v230, v136, v62
    v_fma_f32 v63, v231, v136, v63
    v_exp_f32 v168, v168
    v_exp_f32 v169, v169
    v_exp_f32 v170, v170
    v_exp_f32 v171, v171
    v_fma_f32 v84, v228, v140, v84
    v_fma_f32 v85, v229, v140, v85
    v_fma_f32 v86, v230, v140, v86
    v_fma_f32 v87, v231, v140, v87
    v_exp_f32 v172, v172
    v_exp_f32 v173, v173
    v_exp_f32 v174, v174
    v_exp_f32 v175, v175
    v_fma_f32 v108, v228, v144, v108
    v_fma_f32 v109, v229, v144, v109
    v_fma_f32 v110, v230, v144, v110
    v_fma_f32 v111, v231, v144, v111
    v_exp_f32 v176, v176
    v_exp_f32 v177, v177
    v_exp_f32 v178, v178
    v_exp_f32 v179, v179
    v_fma_f32 v132, v228, v148, v132
    v_fma_f32 v133, v229, v148, v133
    v_fma_f32 v134, v230, v148, v134
    v_fma_f32 v135, v231, v148, v135
    v_exp_f32 v180, v180
    v_exp_f32 v181, v181
    v_exp_f32 v182, v182
    v_exp_f32 v183, v183
    v_mul_f32 v56, v56, v60
    v_mul_f32 v57, v57, v61
    v_mul_f32 v58, v58, v62
    v_mul_f32 v59, v59, v63
    v_mul_f32 v80, v80, v84
    v_mul_f32 v81, v81, v85
    v_mul_f32 v82, v82, v86
    v_mul_f32 v83, v83, v87
    v_mul_f32 v104, v104, v108
    v_mul_f32 v105, v105, v109
    v_mul_f32 v106, v106, v110
    v_mul_f32 v107, v107, v111
    v_mul_f32 v128, v128, v132
    v_mul_f32 v129, v129, v133
    v_mul_f32 v130, v130, v134
    v_mul_f32 v131, v131, v135
    v_add_f32 v168, v168, v138
    v_add_f32 v169, v169, v138
    v_add_f32 v170, v170, v138
    v_add_f32 v171, v171, v138
    v_add_f32 v172, v172, v142
    v_add_f32 v173, v173, v142
    v_add_f32 v174, v174, v142
    v_add_f32 v175, v175, v142
    v_add_f32 v176, v176, v146
    v_add_f32 v177, v177, v146
    v_add_f32 v178, v178, v146
    v_add_f32 v179, v179, v146
    v_add_f32 v180, v180, v150
    v_add_f32 v181, v181, v150
    v_add_f32 v182, v182, v150
    v_add_f32 v183, v183, v150
    v_rcp_f32 v168, v168
    v_rcp_f32 v169, v169
    v_rcp_f32 v170, v170
    v_rcp_f32 v171, v171
    v_rcp_f32 v172, v172
    v_rcp_f32 v173, v173
    v_rcp_f32 v174, v174
    v_rcp_f32 v175, v175
    v_rcp_f32 v176, v176
    v_rcp_f32 v177, v177
    v_rcp_f32 v178, v178
    v_rcp_f32 v179, v179
    v_rcp_f32 v180, v180
    v_rcp_f32 v181, v181
    v_rcp_f32 v182, v182
    v_rcp_f32 v183, v183
    s_nop 0
    v_mul_f32 v56, v56, v168
    v_mul_f32 v57, v57, v169
    v_mul_f32 v58, v58, v170
    v_mul_f32 v59, v59, v171
    v_mul_f32 v80, v80, v172
    v_mul_f32 v81, v81, v173
    v_mul_f32 v82, v82, v174
    v_mul_f32 v83, v83, v175
    v_mul_f32 v104, v104, v176
    v_mul_f32 v105, v105, v177
    v_mul_f32 v106, v106, v178
    v_mul_f32 v107, v107, v179
    v_mul_f32 v128, v128, v180
    v_mul_f32 v129, v129, v181
    v_mul_f32 v130, v130, v182
    v_mul_f32 v131, v131, v183
    v_cvt_pk_bf16_f32 v168, v56, v57
    v_cvt_pk_bf16_f32 v169, v58, v59
    buffer_store_dwordx2 v[168:169], v10, s[56:59], s60 offen sc1
    v_cvt_pk_bf16_f32 v172, v80, v81
    v_cvt_pk_bf16_f32 v173, v82, v83
    buffer_store_dwordx2 v[172:173], v10, s[56:59], s62 offen sc1
    v_cvt_pk_bf16_f32 v176, v104, v105
    v_cvt_pk_bf16_f32 v177, v106, v107
    buffer_store_dwordx2 v[176:177], v10, s[56:59], s61 offen sc1
    v_cvt_pk_bf16_f32 v180, v128, v129
    v_cvt_pk_bf16_f32 v181, v130, v131
    buffer_store_dwordx2 v[180:181], v10, s[56:59], s63 offen sc1
    s_branch L_g1done
L_g1skw:
    s_waitcnt vmcnt(0)
L_g1done:
    s_lshl_b32 s3, s4, 8
    s_lshl_b32 s14, s5, 4
    s_add_u32 s3, s3, s14
    s_add_u32 s3, s3, 8192
    v_mov_b32 v26, s3
    s_waitcnt vmcnt(0)
    s_barrier
    v_cmp_eq_u32 vcc, 0, v0
    s_and_saveexec_b64 s[58:59], vcc
    s_cbranch_execz L_g1f
    global_store_dword v26, v28, s[90:91] sc1
L_g1f:
    s_mov_b64 exec, s[58:59]
    s_branch L_g2
L_idle:
    s_mov_b32 s68, 0
    s_waitcnt lgkmcnt(0)
    s_add_u32 s90, s46, 15990784
    s_addc_u32 s91, s47, 0
    s_and_b32 s100, s2, 1
    s_lshl_b32 s101, s100, 9
    s_lshr_b32 s3, s2, 6
    s_lshl_b32 s3, s3, 7
    s_add_u32 s3, s3, s101
    v_lshrrev_b32 v232, 3, v1
    v_and_b32 v233, 6, v232
    v_and_b32 v234, 7, v1
    v_xor_b32 v233, v233, v234
    v_lshlrev_b32 v232, 10, v232
    v_lshl_add_u32 v232, v233, 4, v232
    v_add_u32 v232, s3, v232
    v_add_u32 v233, 7168, v232
    v_add_u32 v234, 14336, v232
    v_add_u32 v235, 21504, v232
    s_mul_i32 s101, s100, 24
    s_add_u32 s101, s101, s6
    s_lshl_b32 s101, s101, 15
    s_lshl_b32 s100, s6, 14
    s_mov_b32 s96, s40
    s_mov_b32 s97, s41
    s_mov_b32 s98, 1409024
    s_mov_b32 s99, 0x00020000
    s_add_u32 m0, s100, 0
    s_nop 0
    buffer_load_dwordx4 v232, s[96:99], s101 offen offset:0 lds
    buffer_load_dwordx4 v233, s[96:99], s101 offen offset:1024 lds
    buffer_load_dwordx4 v234, s[96:99], s101 offen offset:2048 lds
    buffer_load_dwordx4 v235, s[96:99], s101 offen offset:3072 lds
    s_add_u32 s101, s101, 0x20000
    s_add_u32 m0, s100, 4096
    s_nop 0
    buffer_load_dwordx4 v232, s[96:99], s101 offen offset:0 lds
    buffer_load_dwordx4 v233, s[96:99], s101 offen offset:1024 lds
    buffer_load_dwordx4 v234, s[96:99], s101 offen offset:2048 lds
    buffer_load_dwordx4 v235, s[96:99], s101 offen offset:3072 lds
    s_add_u32 s101, s101, 0x20000
    s_add_u32 m0, s100, 8192
    s_nop 0
    buffer_load_dwordx4 v232, s[96:99], s101 offen offset:0 lds
    buffer_load_dwordx4 v233, s[96:99], s101 offen offset:1024 lds
    buffer_load_dwordx4 v234, s[96:99], s101 offen offset:2048 lds
    buffer_load_dwordx4 v235, s[96:99], s101 offen offset:3072 lds
    s_add_u32 s101, s101, 0x20000
    s_add_u32 m0, s100, 12288
    s_nop 0
    buffer_load_dwordx4 v232, s[96:99], s101 offen offset:0 lds
    buffer_load_dwordx4 v233, s[96:99], s101 offen offset:1024 lds
    buffer_load_dwordx4 v234, s[96:99], s101 offen offset:2048 lds
    buffer_load_dwordx4 v235, s[96:99], s101 offen offset:3072 lds
    s_add_u32 s101, s101, 0x20000
    s_branch L_g2
L_cs:
    v_mov_b32 v16, 0x3f803f80
    v_mov_b32 v17, 0x3f803f80
    v_mov_b32 v18, 0x3f803f80
    v_mov_b32 v19, 0x3f803f80
    v_mov_b32 v40, 0
    v_mov_b32 v41, 0
    v_mov_b32 v42, 0
    v_mov_b32 v43, 0
    v_mov_b32 v44, 0
    v_mov_b32 v45, 0
    v_mov_b32 v46, 0
    v_mov_b32 v47, 0
    v_mov_b32 v48, 0
    v_mov_b32 v49, 0
    v_mov_b32 v50, 0
    v_mov_b32 v51, 0
    v_mov_b32 v52, 0
    v_mov_b32 v53, 0
    v_mov_b32 v54, 0
    v_mov_b32 v55, 0
    v_mov_b32 v56, 0
    v_mov_b32 v57, 0
    v_mov_b32 v58, 0
    v_mov_b32 v59, 0
    v_mov_b32 v60, 0
    v_mov_b32 v61, 0
    v_mov_b32 v62, 0
    v_mov_b32 v63, 0
    s_sub_u32 s69, s10, 24576
    v_subrev_u32 v32, 24576, v13
    v_subrev_u32 v33, 24576, v14
    v_subrev_u32 v34, 24576, v15
    s_add_u32 m0, s10, 36864
    s_nop 0
    buffer_load_dwordx4 v6, s[52:55], s12 offen offset:0 lds
    buffer_load_dwordx4 v7, s[52:55], s12 offen offset:1024 lds
    buffer_load_dwordx4 v8, s[52:55], s12 offen offset:2048 lds
    s_add_u32 s67, s67, 1
    s_and_b32 s67, s67, 15
    s_mul_i32 s12, s67, 88064
    s_add_u32 m0, s69, 0
    s_nop 0
    buffer_load_dwordx4 v6, s[52:55], s12 offen offset:0 lds
    buffer_load_dwordx4 v7, s[52:55], s12 offen offset:1024 lds
    buffer_load_dwordx4 v8, s[52:55], s12 offen offset:2048 lds
    s_add_u32 s67, s67, 1
    s_and_b32 s67, s67, 15
    s_mul_i32 s12, s67, 88064
    s_waitcnt vmcnt(12)
    s_barrier
    s_add_u32 m0, s69, 12288
    s_nop 0
    buffer_load_dwordx4 v6, s[52:55], s12 offen offset:0 lds
    buffer_load_dwordx4 v7, s[52:55], s12 offen offset:1024 lds
    buffer_load_dwordx4 v8, s[52:55], s12 offen offset:2048 lds
    s_add_u32 s67, s67, 1
    s_and_b32 s67, s67, 15
    s_mul_i32 s12, s67, 88064
    ds_read_b64_tr_b16 v[200:201], v13 offset:0
    ds_read_b64_tr_b16 v[202:203], v13 offset:768
    ds_read_b64_tr_b16 v[204:205], v13 offset:6144
    ds_read_b64_tr_b16 v[206:207], v13 offset:6912
    ds_read_b64_tr_b16 v[208:209], v14 offset:0
    ds_read_b64_tr_b16 v[210:211], v14 offset:768
    ds_read_b64_tr_b16 v[212:213], v14 offset:6144
    ds_read_b64_tr_b16 v[214:215], v14 offset:6912
    ds_read_b64_tr_b16 v[216:217], v15 offset:0
    ds_read_b64_tr_b16 v[218:219], v15 offset:768
    ds_read_b64_tr_b16 v[220:221], v15 offset:6144
    ds_read_b64_tr_b16 v[222:223], v15 offset:6912
    s_waitcnt lgkmcnt(10)
    v_mfma_f32_16x16x32_bf16 v[40:43], v[200:203], v[16:19], v[40:43]
    s_waitcnt lgkmcnt(8)
    v_mfma_f32_16x16x32_bf16 v[44:47], v[204:207], v[16:19], v[44:47]
    s_waitcnt lgkmcnt(6)
    v_mfma_f32_16x16x32_bf16 v[48:51], v[208:211], v[16:19], v[48:51]
    s_waitcnt lgkmcnt(4)
    v_mfma_f32_16x16x32_bf16 v[52:55], v[212:215], v[16:19], v[52:55]
    s_waitcnt lgkmcnt(2)
    v_mfma_f32_16x16x32_bf16 v[56:59], v[216:219], v[16:19], v[56:59]
    s_waitcnt lgkmcnt(0)
    v_mfma_f32_16x16x32_bf16 v[60:63], v[220:223], v[16:19], v[60:63]
    s_waitcnt vmcnt(12)
    s_barrier
    s_add_u32 m0, s10, 0
    s_nop 0
    buffer_load_dwordx4 v6, s[52:55], s12 offen offset:0 lds
    buffer_load_dwordx4 v7, s[52:55], s12 offen offset:1024 lds
    buffer_load_dwordx4 v8, s[52:55], s12 offen offset:2048 lds
    s_add_u32 s67, s67, 1
    s_and_b32 s67, s67, 15
    s_mul_i32 s12, s67, 88064
    ds_read_b64_tr_b16 v[200:201], v13 offset:12288
    ds_read_b64_tr_b16 v[202:203], v13 offset:13056
    ds_read_b64_tr_b16 v[204:205], v13 offset:18432
    ds_read_b64_tr_b16 v[206:207], v13 offset:19200
    ds_read_b64_tr_b16 v[208:209], v14 offset:12288
    ds_read_b64_tr_b16 v[210:211], v14 offset:13056
    ds_read_b64_tr_b16 v[212:213], v14 offset:18432
    ds_read_b64_tr_b16 v[214:215], v14 offset:19200
    ds_read_b64_tr_b16 v[216:217], v15 offset:12288
    ds_read_b64_tr_b16 v[218:219], v15 offset:13056
    ds_read_b64_tr_b16 v[220:221], v15 offset:18432
    ds_read_b64_tr_b16 v[222:223], v15 offset:19200
    s_waitcnt lgkmcnt(10)
    v_mfma_f32_16x16x32_bf16 v[40:43], v[200:203], v[16:19], v[40:43]
    s_waitcnt lgkmcnt(8)
    v_mfma_f32_16x16x32_bf16 v[44:47], v[204:207], v[16:19], v[44:47]
    s_waitcnt lgkmcnt(6)
    v_mfma_f32_16x16x32_bf16 v[48:51], v[208:211], v[16:19], v[48:51]
    s_waitcnt lgkmcnt(4)
    v_mfma_f32_16x16x32_bf16 v[52:55], v[212:215], v[16:19], v[52:55]
    s_waitcnt lgkmcnt(2)
    v_mfma_f32_16x16x32_bf16 v[56:59], v[216:219], v[16:19], v[56:59]
    s_waitcnt lgkmcnt(0)
    v_mfma_f32_16x16x32_bf16 v[60:63], v[220:223], v[16:19], v[60:63]
    s_waitcnt vmcnt(12)
    s_barrier
    s_add_u32 m0, s10, 12288
    s_nop 0
    buffer_load_dwordx4 v6, s[52:55], s12 offen offset:0 lds
    buffer_load_dwordx4 v7, s[52:55], s12 offen offset:1024 lds
    buffer_load_dwordx4 v8, s[52:55], s12 offen offset:2048 lds
    s_add_u32 s67, s67, 1
    s_and_b32 s67, s67, 15
    s_mul_i32 s12, s67, 88064
    ds_read_b64_tr_b16 v[200:201], v13 offset:24576
    ds_read_b64_tr_b16 v[202:203], v13 offset:25344
    ds_read_b64_tr_b16 v[204:205], v13 offset:30720
    ds_read_b64_tr_b16 v[206:207], v13 offset:31488
    ds_read_b64_tr_b16 v[208:209], v14 offset:24576
    ds_read_b64_tr_b16 v[210:211], v14 offset:25344
    ds_read_b64_tr_b16 v[212:213], v14 offset:30720
    ds_read_b64_tr_b16 v[214:215], v14 offset:31488
    ds_read_b64_tr_b16 v[216:217], v15 offset:24576
    ds_read_b64_tr_b16 v[218:219], v15 offset:25344
    ds_read_b64_tr_b16 v[220:221], v15 offset:30720
    ds_read_b64_tr_b16 v[222:223], v15 offset:31488
    s_waitcnt lgkmcnt(10)
    v_mfma_f32_16x16x32_bf16 v[40:43], v[200:203], v[16:19], v[40:43]
    s_waitcnt lgkmcnt(8)
    v_mfma_f32_16x16x32_bf16 v[44:47], v[204:207], v[16:19], v[44:47]
    s_waitcnt lgkmcnt(6)
    v_mfma_f32_16x16x32_bf16 v[48:51], v[208:211], v[16:19], v[48:51]
    s_waitcnt lgkmcnt(4)
    v_mfma_f32_16x16x32_bf16 v[52:55], v[212:215], v[16:19], v[52:55]
    s_waitcnt lgkmcnt(2)
    v_mfma_f32_16x16x32_bf16 v[56:59], v[216:219], v[16:19], v[56:59]
    s_waitcnt lgkmcnt(0)
    v_mfma_f32_16x16x32_bf16 v[60:63], v[220:223], v[16:19], v[60:63]
    s_waitcnt vmcnt(12)
    s_barrier
    s_add_u32 m0, s10, 24576
    s_nop 0
    buffer_load_dwordx4 v6, s[52:55], s12 offen offset:0 lds
    buffer_load_dwordx4 v7, s[52:55], s12 offen offset:1024 lds
    buffer_load_dwordx4 v8, s[52:55], s12 offen offset:2048 lds
    s_add_u32 s67, s67, 1
    s_and_b32 s67, s67, 15
    s_mul_i32 s12, s67, 88064
    ds_read_b64_tr_b16 v[200:201], v13 offset:36864
    ds_read_b64_tr_b16 v[202:203], v13 offset:37632
    ds_read_b64_tr_b16 v[204:205], v13 offset:43008
    ds_read_b64_tr_b16 v[206:207], v13 offset:43776
    ds_read_b64_tr_b16 v[208:209], v14 offset:36864
    ds_read_b64_tr_b16 v[210:211], v14 offset:37632
    ds_read_b64_tr_b16 v[212:213], v14 offset:43008
    ds_read_b64_tr_b16 v[214:215], v14 offset:43776
    ds_read_b64_tr_b16 v[216:217], v15 offset:36864
    ds_read_b64_tr_b16 v[218:219], v15 offset:37632
    ds_read_b64_tr_b16 v[220:221], v15 offset:43008
    ds_read_b64_tr_b16 v[222:223], v15 offset:43776
    s_waitcnt lgkmcnt(10)
    v_mfma_f32_16x16x32_bf16 v[40:43], v[200:203], v[16:19], v[40:43]
    s_waitcnt lgkmcnt(8)
    v_mfma_f32_16x16x32_bf16 v[44:47], v[204:207], v[16:19], v[44:47]
    s_waitcnt lgkmcnt(6)
    v_mfma_f32_16x16x32_bf16 v[48:51], v[208:211], v[16:19], v[48:51]
    s_waitcnt lgkmcnt(4)
    v_mfma_f32_16x16x32_bf16 v[52:55], v[212:215], v[16:19], v[52:55]
    s_waitcnt lgkmcnt(2)
    v_mfma_f32_16x16x32_bf16 v[56:59], v[216:219], v[16:19], v[56:59]
    s_waitcnt lgkmcnt(0)
    v_mfma_f32_16x16x32_bf16 v[60:63], v[220:223], v[16:19], v[60:63]
    s_waitcnt vmcnt(12)
    s_barrier
    s_add_u32 m0, s10, 36864
    s_nop 0
    buffer_load_dwordx4 v6, s[52:55], s12 offen offset:0 lds
    buffer_load_dwordx4 v7, s[52:55], s12 offen offset:1024 lds
    buffer_load_dwordx4 v8, s[52:55], s12 offen offset:2048 lds
    s_add_u32 s67, s67, 1
    s_and_b32 s67, s67, 15
    s_mul_i32 s12, s67, 88064
    ds_read_b64_tr_b16 v[200:201], v32 offset:0
    ds_read_b64_tr_b16 v[202:203], v32 offset:768
    ds_read_b64_tr_b16 v[204:205], v32 offset:6144
    ds_read_b64_tr_b16 v[206:207], v32 offset:6912
    ds_read_b64_tr_b16 v[208:209], v33 offset:0
    ds_read_b64_tr_b16 v[210:211], v33 offset:768
    ds_read_b64_tr_b16 v[212:213], v33 offset:6144
    ds_read_b64_tr_b16 v[214:215], v33 offset:6912
    ds_read_b64_tr_b16 v[216:217], v34 offset:0
    ds_read_b64_tr_b16 v[218:219], v34 offset:768
    ds_read_b64_tr_b16 v[220:221], v34 offset:6144
    ds_read_b64_tr_b16 v[222:223], v34 offset:6912
    s_waitcnt lgkmcnt(10)
    v_mfma_f32_16x16x32_bf16 v[40:43], v[200:203], v[16:19], v[40:43]
    s_waitcnt lgkmcnt(8)
    v_mfma_f32_16x16x32_bf16 v[44:47], v[204:207], v[16:19], v[44:47]
    s_waitcnt lgkmcnt(6)
    v_mfma_f32_16x16x32_bf16 v[48:51], v[208:211], v[16:19], v[48:51]
    s_waitcnt lgkmcnt(4)
    v_mfma_f32_16x16x32_bf16 v[52:55], v[212:215], v[16:19], v[52:55]
    s_waitcnt lgkmcnt(2)
    v_mfma_f32_16x16x32_bf16 v[56:59], v[216:219], v[16:19], v[56:59]
    s_waitcnt lgkmcnt(0)
    v_mfma_f32_16x16x32_bf16 v[60:63], v[220:223], v[16:19], v[60:63]
    s_waitcnt vmcnt(12)
    s_barrier
    s_add_u32 m0, s69, 0
    s_nop 0
    buffer_load_dwordx4 v6, s[52:55], s12 offen offset:0 lds
    buffer_load_dwordx4 v7, s[52:55], s12 offen offset:1024 lds
    buffer_load_dwordx4 v8, s[52:55], s12 offen offset:2048 lds
    s_add_u32 s67, s67, 1
    s_and_b32 s67, s67, 15
    s_mul_i32 s12, s67, 88064
    ds_read_b64_tr_b16 v[200:201], v32 offset:12288
    ds_read_b64_tr_b16 v[202:203], v32 offset:13056
    ds_read_b64_tr_b16 v[204:205], v32 offset:18432
    ds_read_b64_tr_b16 v[206:207], v32 offset:19200
    ds_read_b64_tr_b16 v[208:209], v33 offset:12288
    ds_read_b64_tr_b16 v[210:211], v33 offset:13056
    ds_read_b64_tr_b16 v[212:213], v33 offset:18432
    ds_read_b64_tr_b16 v[214:215], v33 offset:19200
    ds_read_b64_tr_b16 v[216:217], v34 offset:12288
    ds_read_b64_tr_b16 v[218:219], v34 offset:13056
    ds_read_b64_tr_b16 v[220:221], v34 offset:18432
    ds_read_b64_tr_b16 v[222:223], v34 offset:19200
    s_waitcnt lgkmcnt(10)
    v_mfma_f32_16x16x32_bf16 v[40:43], v[200:203], v[16:19], v[40:43]
    s_waitcnt lgkmcnt(8)
    v_mfma_f32_16x16x32_bf16 v[44:47], v[204:207], v[16:19], v[44:47]
    s_waitcnt lgkmcnt(6)
    v_mfma_f32_16x16x32_bf16 v[48:51], v[208:211], v[16:19], v[48:51]
    s_waitcnt lgkmcnt(4)
    v_mfma_f32_16x16x32_bf16 v[52:55], v[212:215], v[16:19], v[52:55]
    s_waitcnt lgkmcnt(2)
    v_mfma_f32_16x16x32_bf16 v[56:59], v[216:219], v[16:19], v[56:59]
    s_waitcnt lgkmcnt(0)
    v_mfma_f32_16x16x32_bf16 v[60:63], v[220:223], v[16:19], v[60:63]
    s_waitcnt vmcnt(12)
    s_barrier
    s_add_u32 m0, s69, 12288
    s_nop 0
    buffer_load_dwordx4 v6, s[52:55], s12 offen offset:0 lds
    buffer_load_dwordx4 v7, s[52:55], s12 offen offset:1024 lds
    buffer_load_dwordx4 v8, s[52:55], s12 offen offset:2048 lds
    s_add_u32 s67, s67, 1
    s_and_b32 s67, s67, 15
    s_mul_i32 s12, s67, 88064
    ds_read_b64_tr_b16 v[200:201], v13 offset:0
    ds_read_b64_tr_b16 v[202:203], v13 offset:768
    ds_read_b64_tr_b16 v[204:205], v13 offset:6144
    ds_read_b64_tr_b16 v[206:207], v13 offset:6912
    ds_read_b64_tr_b16 v[208:209], v14 offset:0
    ds_read_b64_tr_b16 v[210:211], v14 offset:768
    ds_read_b64_tr_b16 v[212:213], v14 offset:6144
    ds_read_b64_tr_b16 v[214:215], v14 offset:6912
    ds_read_b64_tr_b16 v[216:217], v15 offset:0
    ds_read_b64_tr_b16 v[218:219], v15 offset:768
    ds_read_b64_tr_b16 v[220:221], v15 offset:6144
    ds_read_b64_tr_b16 v[222:223], v15 offset:6912
    s_waitcnt lgkmcnt(10)
    v_mfma_f32_16x16x32_bf16 v[40:43], v[200:203], v[16:19], v[40:43]
    s_waitcnt lgkmcnt(8)
    v_mfma_f32_16x16x32_bf16 v[44:47], v[204:207], v[16:19], v[44:47]
    s_waitcnt lgkmcnt(6)
    v_mfma_f32_16x16x32_bf16 v[48:51], v[208:211], v[16:19], v[48:51]
    s_waitcnt lgkmcnt(4)
    v_mfma_f32_16x16x32_bf16 v[52:55], v[212:215], v[16:19], v[52:55]
    s_waitcnt lgkmcnt(2)
    v_mfma_f32_16x16x32_bf16 v[56:59], v[216:219], v[16:19], v[56:59]
    s_waitcnt lgkmcnt(0)
    v_mfma_f32_16x16x32_bf16 v[60:63], v[220:223], v[16:19], v[60:63]
    s_waitcnt vmcnt(12)
    s_barrier
    s_add_u32 m0, s10, 0
    s_nop 0
    buffer_load_dwordx4 v6, s[52:55], s12 offen offset:0 lds
    buffer_load_dwordx4 v7, s[52:55], s12 offen offset:1024 lds
    buffer_load_dwordx4 v8, s[52:55], s12 offen offset:2048 lds
    s_add_u32 s67, s67, 1
    s_and_b32 s67, s67, 15
    s_mul_i32 s12, s67, 88064
    ds_read_b64_tr_b16 v[200:201], v13 offset:12288
    ds_read_b64_tr_b16 v[202:203], v13 offset:13056
    ds_read_b64_tr_b16 v[204:205], v13 offset:18432
    ds_read_b64_tr_b16 v[206:207], v13 offset:19200
    ds_read_b64_tr_b16 v[208:209], v14 offset:12288
    ds_read_b64_tr_b16 v[210:211], v14 offset:13056
    ds_read_b64_tr_b16 v[212:213], v14 offset:18432
    ds_read_b64_tr_b16 v[214:215], v14 offset:19200
    ds_read_b64_tr_b16 v[216:217], v15 offset:12288
    ds_read_b64_tr_b16 v[218:219], v15 offset:13056
    ds_read_b64_tr_b16 v[220:221], v15 offset:18432
    ds_read_b64_tr_b16 v[222:223], v15 offset:19200
    s_waitcnt lgkmcnt(10)
    v_mfma_f32_16x16x32_bf16 v[40:43], v[200:203], v[16:19], v[40:43]
    s_waitcnt lgkmcnt(8)
    v_mfma_f32_16x16x32_bf16 v[44:47], v[204:207], v[16:19], v[44:47]
    s_waitcnt lgkmcnt(6)
    v_mfma_f32_16x16x32_bf16 v[48:51], v[208:211], v[16:19], v[48:51]
    s_waitcnt lgkmcnt(4)
    v_mfma_f32_16x16x32_bf16 v[52:55], v[212:215], v[16:19], v[52:55]
    s_waitcnt lgkmcnt(2)
    v_mfma_f32_16x16x32_bf16 v[56:59], v[216:219], v[16:19], v[56:59]
    s_waitcnt lgkmcnt(0)
    v_mfma_f32_16x16x32_bf16 v[60:63], v[220:223], v[16:19], v[60:63]
    s_waitcnt vmcnt(12)
    s_barrier
    s_add_u32 m0, s10, 12288
    s_nop 0
    buffer_load_dwordx4 v6, s[52:55], s12 offen offset:0 lds
    buffer_load_dwordx4 v7, s[52:55], s12 offen offset:1024 lds
    buffer_load_dwordx4 v8, s[52:55], s12 offen offset:2048 lds
    s_add_u32 s67, s67, 1
    s_and_b32 s67, s67, 15
    s_mul_i32 s12, s67, 88064
    ds_read_b64_tr_b16 v[200:201], v13 offset:24576
    ds_read_b64_tr_b16 v[202:203], v13 offset:25344
    ds_read_b64_tr_b16 v[204:205], v13 offset:30720
    ds_read_b64_tr_b16 v[206:207], v13 offset:31488
    ds_read_b64_tr_b16 v[208:209], v14 offset:24576
    ds_read_b64_tr_b16 v[210:211], v14 offset:25344
    ds_read_b64_tr_b16 v[212:213], v14 offset:30720
    ds_read_b64_tr_b16 v[214:215], v14 offset:31488
    ds_read_b64_tr_b16 v[216:217], v15 offset:24576
    ds_read_b64_tr_b16 v[218:219], v15 offset:25344
    ds_read_b64_tr_b16 v[220:221], v15 offset:30720
    ds_read_b64_tr_b16 v[222:223], v15 offset:31488
    s_waitcnt lgkmcnt(10)
    v_mfma_f32_16x16x32_bf16 v[40:43], v[200:203], v[16:19], v[40:43]
    s_waitcnt lgkmcnt(8)
    v_mfma_f32_16x16x32_bf16 v[44:47], v[204:207], v[16:19], v[44:47]
    s_waitcnt lgkmcnt(6)
    v_mfma_f32_16x16x32_bf16 v[48:51], v[208:211], v[16:19], v[48:51]
    s_waitcnt lgkmcnt(4)
    v_mfma_f32_16x16x32_bf16 v[52:55], v[212:215], v[16:19], v[52:55]
    s_waitcnt lgkmcnt(2)
    v_mfma_f32_16x16x32_bf16 v[56:59], v[216:219], v[16:19], v[56:59]
    s_waitcnt lgkmcnt(0)
    v_mfma_f32_16x16x32_bf16 v[60:63], v[220:223], v[16:19], v[60:63]
    s_waitcnt vmcnt(12)
    s_barrier
    s_add_u32 m0, s10, 24576
    s_nop 0
    buffer_load_dwordx4 v6, s[52:55], s12 offen offset:0 lds
    buffer_load_dwordx4 v7, s[52:55], s12 offen offset:1024 lds
    buffer_load_dwordx4 v8, s[52:55], s12 offen offset:2048 lds
    s_add_u32 s67, s67, 1
    s_and_b32 s67, s67, 15
    s_mul_i32 s12, s67, 88064
    ds_read_b64_tr_b16 v[200:201], v13 offset:36864
    ds_read_b64_tr_b16 v[202:203], v13 offset:37632
    ds_read_b64_tr_b16 v[204:205], v13 offset:43008
    ds_read_b64_tr_b16 v[206:207], v13 offset:43776
    ds_read_b64_tr_b16 v[208:209], v14 offset:36864
    ds_read_b64_tr_b16 v[210:211], v14 offset:37632
    ds_read_b64_tr_b16 v[212:213], v14 offset:43008
    ds_read_b64_tr_b16 v[214:215], v14 offset:43776
    ds_read_b64_tr_b16 v[216:217], v15 offset:36864
    ds_read_b64_tr_b16 v[218:219], v15 offset:37632
    ds_read_b64_tr_b16 v[220:221], v15 offset:43008
    ds_read_b64_tr_b16 v[222:223], v15 offset:43776
    s_waitcnt lgkmcnt(10)
    v_mfma_f32_16x16x32_bf16 v[40:43], v[200:203], v[16:19], v[40:43]
    s_waitcnt lgkmcnt(8)
    v_mfma_f32_16x16x32_bf16 v[44:47], v[204:207], v[16:19], v[44:47]
    s_waitcnt lgkmcnt(6)
    v_mfma_f32_16x16x32_bf16 v[48:51], v[208:211], v[16:19], v[48:51]
    s_waitcnt lgkmcnt(4)
    v_mfma_f32_16x16x32_bf16 v[52:55], v[212:215], v[16:19], v[52:55]
    s_waitcnt lgkmcnt(2)
    v_mfma_f32_16x16x32_bf16 v[56:59], v[216:219], v[16:19], v[56:59]
    s_waitcnt lgkmcnt(0)
    v_mfma_f32_16x16x32_bf16 v[60:63], v[220:223], v[16:19], v[60:63]
    s_waitcnt vmcnt(12)
    s_barrier
    s_add_u32 m0, s10, 36864
    s_nop 0
    buffer_load_dwordx4 v6, s[52:55], s12 offen offset:0 lds
    buffer_load_dwordx4 v7, s[52:55], s12 offen offset:1024 lds
    buffer_load_dwordx4 v8, s[52:55], s12 offen offset:2048 lds
    s_add_u32 s67, s67, 1
    s_and_b32 s67, s67, 15
    s_mul_i32 s12, s67, 88064
    ds_read_b64_tr_b16 v[200:201], v32 offset:0
    ds_read_b64_tr_b16 v[202:203], v32 offset:768
    ds_read_b64_tr_b16 v[204:205], v32 offset:6144
    ds_read_b64_tr_b16 v[206:207], v32 offset:6912
    ds_read_b64_tr_b16 v[208:209], v33 offset:0
    ds_read_b64_tr_b16 v[210:211], v33 offset:768
    ds_read_b64_tr_b16 v[212:213], v33 offset:6144
    ds_read_b64_tr_b16 v[214:215], v33 offset:6912
    ds_read_b64_tr_b16 v[216:217], v34 offset:0
    ds_read_b64_tr_b16 v[218:219], v34 offset:768
    ds_read_b64_tr_b16 v[220:221], v34 offset:6144
    ds_read_b64_tr_b16 v[222:223], v34 offset:6912
    s_waitcnt lgkmcnt(10)
    v_mfma_f32_16x16x32_bf16 v[40:43], v[200:203], v[16:19], v[40:43]
    s_waitcnt lgkmcnt(8)
    v_mfma_f32_16x16x32_bf16 v[44:47], v[204:207], v[16:19], v[44:47]
    s_waitcnt lgkmcnt(6)
    v_mfma_f32_16x16x32_bf16 v[48:51], v[208:211], v[16:19], v[48:51]
    s_waitcnt lgkmcnt(4)
    v_mfma_f32_16x16x32_bf16 v[52:55], v[212:215], v[16:19], v[52:55]
    s_waitcnt lgkmcnt(2)
    v_mfma_f32_16x16x32_bf16 v[56:59], v[216:219], v[16:19], v[56:59]
    s_waitcnt lgkmcnt(0)
    v_mfma_f32_16x16x32_bf16 v[60:63], v[220:223], v[16:19], v[60:63]
    s_waitcnt vmcnt(12)
    s_barrier
    ds_read_b64_tr_b16 v[200:201], v32 offset:12288
    ds_read_b64_tr_b16 v[202:203], v32 offset:13056
    ds_read_b64_tr_b16 v[204:205], v32 offset:18432
    ds_read_b64_tr_b16 v[206:207], v32 offset:19200
    ds_read_b64_tr_b16 v[208:209], v33 offset:12288
    ds_read_b64_tr_b16 v[210:211], v33 offset:13056
    ds_read_b64_tr_b16 v[212:213], v33 offset:18432
    ds_read_b64_tr_b16 v[214:215], v33 offset:19200
    ds_read_b64_tr_b16 v[216:217], v34 offset:12288
    ds_read_b64_tr_b16 v[218:219], v34 offset:13056
    ds_read_b64_tr_b16 v[220:221], v34 offset:18432
    ds_read_b64_tr_b16 v[222:223], v34 offset:19200
    s_waitcnt lgkmcnt(10)
    v_mfma_f32_16x16x32_bf16 v[40:43], v[200:203], v[16:19], v[40:43]
    s_waitcnt lgkmcnt(8)
    v_mfma_f32_16x16x32_bf16 v[44:47], v[204:207], v[16:19], v[44:47]
    s_waitcnt lgkmcnt(6)
    v_mfma_f32_16x16x32_bf16 v[48:51], v[208:211], v[16:19], v[48:51]
    s_waitcnt lgkmcnt(4)
    v_mfma_f32_16x16x32_bf16 v[52:55], v[212:215], v[16:19], v[52:55]
    s_waitcnt lgkmcnt(2)
    v_mfma_f32_16x16x32_bf16 v[56:59], v[216:219], v[16:19], v[56:59]
    s_waitcnt lgkmcnt(0)
    v_mfma_f32_16x16x32_bf16 v[60:63], v[220:223], v[16:19], v[60:63]
    s_waitcnt vmcnt(9)
    s_barrier
    ds_read_b64_tr_b16 v[200:201], v13 offset:0
    ds_read_b64_tr_b16 v[202:203], v13 offset:768
    ds_read_b64_tr_b16 v[204:205], v13 offset:6144
    ds_read_b64_tr_b16 v[206:207], v13 offset:6912
    ds_read_b64_tr_b16 v[208:209], v14 offset:0
    ds_read_b64_tr_b16 v[210:211], v14 offset:768
    ds_read_b64_tr_b16 v[212:213], v14 offset:6144
    ds_read_b64_tr_b16 v[214:215], v14 offset:6912
    ds_read_b64_tr_b16 v[216:217], v15 offset:0
    ds_read_b64_tr_b16 v[218:219], v15 offset:768
    ds_read_b64_tr_b16 v[220:221], v15 offset:6144
    ds_read_b64_tr_b16 v[222:223], v15 offset:6912
    s_waitcnt lgkmcnt(10)
    v_mfma_f32_16x16x32_bf16 v[40:43], v[200:203], v[16:19], v[40:43]
    s_waitcnt lgkmcnt(8)
    v_mfma_f32_16x16x32_bf16 v[44:47], v[204:207], v[16:19], v[44:47]
    s_waitcnt lgkmcnt(6)
    v_mfma_f32_16x16x32_bf16 v[48:51], v[208:211], v[16:19], v[48:51]
    s_waitcnt lgkmcnt(4)
    v_mfma_f32_16x16x32_bf16 v[52:55], v[212:215], v[16:19], v[52:55]
    s_waitcnt lgkmcnt(2)
    v_mfma_f32_16x16x32_bf16 v[56:59], v[216:219], v[16:19], v[56:59]
    s_waitcnt lgkmcnt(0)
    v_mfma_f32_16x16x32_bf16 v[60:63], v[220:223], v[16:19], v[60:63]
    s_waitcnt vmcnt(6)
    s_barrier
    ds_read_b64_tr_b16 v[200:201], v13 offset:12288
    ds_read_b64_tr_b16 v[202:203], v13 offset:13056
    ds_read_b64_tr_b16 v[204:205], v13 offset:18432
    ds_read_b64_tr_b16 v[206:207], v13 offset:19200
    ds_read_b64_tr_b16 v[208:209], v14 offset:12288
    ds_read_b64_tr_b16 v[210:211], v14 offset:13056
    ds_read_b64_tr_b16 v[212:213], v14 offset:18432
    ds_read_b64_tr_b16 v[214:215], v14 offset:19200
    ds_read_b64_tr_b16 v[216:217], v15 offset:12288
    ds_read_b64_tr_b16 v[218:219], v15 offset:13056
    ds_read_b64_tr_b16 v[220:221], v15 offset:18432
    ds_read_b64_tr_b16 v[222:223], v15 offset:19200
    s_waitcnt lgkmcnt(10)
    v_mfma_f32_16x16x32_bf16 v[40:43], v[200:203], v[16:19], v[40:43]
    s_waitcnt lgkmcnt(8)
    v_mfma_f32_16x16x32_bf16 v[44:47], v[204:207], v[16:19], v[44:47]
    s_waitcnt lgkmcnt(6)
    v_mfma_f32_16x16x32_bf16 v[48:51], v[208:211], v[16:19], v[48:51]
    s_waitcnt lgkmcnt(4)
    v_mfma_f32_16x16x32_bf16 v[52:55], v[212:215], v[16:19], v[52:55]
    s_waitcnt lgkmcnt(2)
    v_mfma_f32_16x16x32_bf16 v[56:59], v[216:219], v[16:19], v[56:59]
    s_waitcnt lgkmcnt(0)
    v_mfma_f32_16x16x32_bf16 v[60:63], v[220:223], v[16:19], v[60:63]
    s_waitcnt vmcnt(3)
    s_barrier
    ds_read_b64_tr_b16 v[200:201], v13 offset:24576
    ds_read_b64_tr_b16 v[202:203], v13 offset:25344
    ds_read_b64_tr_b16 v[204:205], v13 offset:30720
    ds_read_b64_tr_b16 v[206:207], v13 offset:31488
    ds_read_b64_tr_b16 v[208:209], v14 offset:24576
    ds_read_b64_tr_b16 v[210:211], v14 offset:25344
    ds_read_b64_tr_b16 v[212:213], v14 offset:30720
    ds_read_b64_tr_b16 v[214:215], v14 offset:31488
    ds_read_b64_tr_b16 v[216:217], v15 offset:24576
    ds_read_b64_tr_b16 v[218:219], v15 offset:25344
    ds_read_b64_tr_b16 v[220:221], v15 offset:30720
    ds_read_b64_tr_b16 v[222:223], v15 offset:31488
    s_waitcnt lgkmcnt(10)
    v_mfma_f32_16x16x32_bf16 v[40:43], v[200:203], v[16:19], v[40:43]
    s_waitcnt lgkmcnt(8)
    v_mfma_f32_16x16x32_bf16 v[44:47], v[204:207], v[16:19], v[44:47]
    s_waitcnt lgkmcnt(6)
    v_mfma_f32_16x16x32_bf16 v[48:51], v[208:211], v[16:19], v[48:51]
    s_waitcnt lgkmcnt(4)
    v_mfma_f32_16x16x32_bf16 v[52:55], v[212:215], v[16:19], v[52:55]
    s_waitcnt lgkmcnt(2)
    v_mfma_f32_16x16x32_bf16 v[56:59], v[216:219], v[16:19], v[56:59]
    s_waitcnt lgkmcnt(0)
    v_mfma_f32_16x16x32_bf16 v[60:63], v[220:223], v[16:19], v[60:63]
    s_waitcnt vmcnt(0)
    s_barrier
    ds_read_b64_tr_b16 v[200:201], v13 offset:36864
    ds_read_b64_tr_b16 v[202:203], v13 offset:37632
    ds_read_b64_tr_b16 v[204:205], v13 offset:43008
    ds_read_b64_tr_b16 v[206:207], v13 offset:43776
    ds_read_b64_tr_b16 v[208:209], v14 offset:36864
    ds_read_b64_tr_b16 v[210:211], v14 offset:37632
    ds_read_b64_tr_b16 v[212:213], v14 offset:43008
    ds_read_b64_tr_b16 v[214:215], v14 offset:43776
    ds_read_b64_tr_b16 v[216:217], v15 offset:36864
    ds_read_b64_tr_b16 v[218:219], v15 offset:37632
    ds_read_b64_tr_b16 v[220:221], v15 offset:43008
    ds_read_b64_tr_b16 v[222:223], v15 offset:43776
    s_waitcnt lgkmcnt(10)
    v_mfma_f32_16x16x32_bf16 v[40:43], v[200:203], v[16:19], v[40:43]
    s_waitcnt lgkmcnt(8)
    v_mfma_f32_16x16x32_bf16 v[44:47], v[204:207], v[16:19], v[44:47]
    s_waitcnt lgkmcnt(6)
    v_mfma_f32_16x16x32_bf16 v[48:51], v[208:211], v[16:19], v[48:51]
    s_waitcnt lgkmcnt(4)
    v_mfma_f32_16x16x32_bf16 v[52:55], v[212:215], v[16:19], v[52:55]
    s_waitcnt lgkmcnt(2)
    v_mfma_f32_16x16x32_bf16 v[56:59], v[216:219], v[16:19], v[56:59]
    s_waitcnt lgkmcnt(0)
    v_mfma_f32_16x16x32_bf16 v[60:63], v[220:223], v[16:19], v[60:63]
    s_add_u32 s62, s46, 15925248
    s_addc_u32 s63, s47, 0
    s_mul_i32 s3, s5, 768
    s_mul_i32 s14, s8, 384
    s_add_u32 s3, s3, s14
    v_lshl_add_u32 v31, v20, 4, s3
    s_add_u32 s90, s46, 15990784
    s_addc_u32 s91, s47, 0
    s_lshl_b32 s3, s5, 4
    s_add_u32 s3, s3, 4096
    v_mov_b32 v26, s3
    v_mov_b32 v29, 0
    v_cmp_eq_u32 vcc, 0, v21
    s_and_saveexec_b64 s[58:59], vcc
    s_nop 2
    global_store_dwordx4 v31, v[40:43], s[62:63] offset:0 sc1
    global_store_dwordx4 v31, v[44:47], s[62:63] offset:64 sc1
    global_store_dwordx4 v31, v[48:51], s[62:63] offset:128 sc1
    global_store_dwordx4 v31, v[52:55], s[62:63] offset:192 sc1
    global_store_dwordx4 v31, v[56:59], s[62:63] offset:256 sc1
    global_store_dwordx4 v31, v[60:63], s[62:63] offset:320 sc1
    s_mov_b64 exec, s[58:59]
    s_mov_b32 s14, 0
L_csn:
    global_load_dword v28, v29, s[44:45] sc1
    s_waitcnt vmcnt(0)
    v_cmp_eq_u32 vcc, 0, v28
    s_add_u32 s14, s14, 1
    s_cmp_gt_u32 s14, 0x200000
    s_cbranch_scc1 L_csn2
    s_cbranch_vccnz L_csn
L_csn2:
    s_barrier
    v_cmp_eq_u32 vcc, 0, v0
    s_and_saveexec_b64 s[58:59], vcc
    s_cbranch_execz L_csf
    global_store_dword v26, v28, s[90:91] sc1
L_csf:
    s_mov_b32 s68, 0
    s_mov_b64 exec, s[58:59]
    s_and_b32 s100, s2, 1
    s_lshl_b32 s101, s100, 9
    s_lshr_b32 s3, s2, 6
    s_lshl_b32 s3, s3, 7
    s_add_u32 s3, s3, s101
    v_lshrrev_b32 v232, 3, v1
    v_and_b32 v233, 6, v232
    v_and_b32 v234, 7, v1
    v_xor_b32 v233, v233, v234
    v_lshlrev_b32 v232, 10, v232
    v_lshl_add_u32 v232, v233, 4, v232
    v_add_u32 v232, s3, v232
    v_add_u32 v233, 7168, v232
    v_add_u32 v234, 14336, v232
    v_add_u32 v235, 21504, v232
    s_mul_i32 s101, s100, 24
    s_add_u32 s101, s101, s6
    s_lshl_b32 s101, s101, 15
    s_lshl_b32 s100, s6, 14
    s_mov_b32 s96, s40
    s_mov_b32 s97, s41
    s_mov_b32 s98, 1409024
    s_mov_b32 s99, 0x00020000
    s_add_u32 m0, s100, 0
    s_nop 0
    buffer_load_dwordx4 v232, s[96:99], s101 offen offset:0 lds
    buffer_load_dwordx4 v233, s[96:99], s101 offen offset:1024 lds
    buffer_load_dwordx4 v234, s[96:99], s101 offen offset:2048 lds
    buffer_load_dwordx4 v235, s[96:99], s101 offen offset:3072 lds
    s_add_u32 s101, s101, 0x20000
    s_add_u32 m0, s100, 4096
    s_nop 0
    buffer_load_dwordx4 v232, s[96:99], s101 offen offset:0 lds
    buffer_load_dwordx4 v233, s[96:99], s101 offen offset:1024 lds
    buffer_load_dwordx4 v234, s[96:99], s101 offen offset:2048 lds
    buffer_load_dwordx4 v235, s[96:99], s101 offen offset:3072 lds
    s_add_u32 s101, s101, 0x20000
    s_add_u32 m0, s100, 8192
    s_nop 0
    buffer_load_dwordx4 v232, s[96:99], s101 offen offset:0 lds
    buffer_load_dwordx4 v233, s[96:99], s101 offen offset:1024 lds
    buffer_load_dwordx4 v234, s[96:99], s101 offen offset:2048 lds
    buffer_load_dwordx4 v235, s[96:99], s101 offen offset:3072 lds
    s_add_u32 s101, s101, 0x20000
    s_add_u32 m0, s100, 12288
    s_nop 0
    buffer_load_dwordx4 v232, s[96:99], s101 offen offset:0 lds
    buffer_load_dwordx4 v233, s[96:99], s101 offen offset:1024 lds
    buffer_load_dwordx4 v234, s[96:99], s101 offen offset:2048 lds
    buffer_load_dwordx4 v235, s[96:99], s101 offen offset:3072 lds
    s_add_u32 s101, s101, 0x20000
    s_branch L_g2
L_g2:
    s_setprio 1
    s_and_b32 s4, s2, 7
    s_lshr_b32 s5, s2, 3
    s_lshr_b32 s7, s4, 1
    s_lshl_b32 s7, s7, 3
    s_and_b32 s3, s5, 7
    s_add_u32 s7, s7, s3
    s_and_b32 s15, s4, 1
    s_lshl_b32 s8, s15, 2
    s_lshr_b32 s3, s5, 3
    s_add_u32 s8, s8, s3
    s_lshr_b32 s3, s7, 1
    s_lshl_b32 s3, s3, 8
    s_add_u32 s3, s3, 8192
    v_min_u32 v5, 14, v1
    v_lshl_add_u32 v5, v5, 4, s3
    v_mov_b32 v23, 0
    s_and_b32 s9, s6, 1
    s_lshr_b32 s10, s6, 1
    v_lshlrev_b32 v2, 4, v1
    s_mul_i32 s3, s10, 88064
    v_add_u32 v3, s3, v2
    s_xor_b32 s11, s10, 1
    s_mul_i32 s3, s11, 88064
    v_add_u32 v4, s3, v2
    s_mul_i32 s3, s15, 24
    s_add_u32 s3, s3, s6
    s_mul_i32 s11, s7, 172
    s_add_u32 s11, s11, s3
    s_lshl_b32 s11, s11, 10
    s_add_u32 s57, s11, 44032
    s_mul_i32 s60, s15, 45056
    s_mul_i32 s61, s15, 1441792
    s_mov_b32 s13, s100
    s_mov_b32 s48, s46
    s_mov_b32 s49, s47
    s_mov_b32 s50, 5636096
    s_mov_b32 s51, 0x00020000
    v_lshrrev_b32 v13, 2, v1
    v_bfe_u32 v14, v1, 3, 2
    s_lshl_b32 s3, s9, 1
    v_xor_b32 v14, s3, v14
    v_lshlrev_b32 v9, 7, v13
    v_lshl_add_u32 v9, v14, 5, v9
    v_and_b32 v14, 3, v1
    v_lshl_add_u32 v9, v14, 3, v9
    v_add_u32 v9, s13, v9
    v_xor_b32 v10, 32, v9
    v_xor_b32 v11, 64, v9
    v_xor_b32 v12, 96, v9
    s_lshl_b32 s3, s7, 16
    s_lshl_b32 s62, s10, 15
    s_add_u32 s3, s3, s62
    s_lshl_b32 s62, s8, 7
    s_add_u32 s3, s3, s62
    s_lshl_b32 s62, s9, 6
    s_add_u32 s62, s3, s62
    v_and_b32 v15, 15, v1
    v_lshrrev_b32 v16, 4, v1
    v_lshlrev_b32 v17, 10, v15
    v_lshl_add_u32 v18, v16, 3, v17
    v_add_u32 v18, s62, v18
    v_add_u32 v19, 0x4000, v18
    s_waitcnt vmcnt(0)
    ds_read_b64_tr_b16 v[168:169], v9 offset:0
    ds_read_b64_tr_b16 v[170:171], v9 offset:2048
    ds_read_b64_tr_b16 v[172:173], v10 offset:0
    ds_read_b64_tr_b16 v[174:175], v10 offset:2048
    ds_read_b64_tr_b16 v[176:177], v11 offset:0
    ds_read_b64_tr_b16 v[178:179], v11 offset:2048
    ds_read_b64_tr_b16 v[180:181], v12 offset:0
    ds_read_b64_tr_b16 v[182:183], v12 offset:2048
    ds_read_b64_tr_b16 v[184:185], v9 offset:4096
    ds_read_b64_tr_b16 v[186:187], v9 offset:6144
    ds_read_b64_tr_b16 v[188:189], v10 offset:4096
    ds_read_b64_tr_b16 v[190:191], v10 offset:6144
    ds_read_b64_tr_b16 v[192:193], v11 offset:4096
    ds_read_b64_tr_b16 v[194:195], v11 offset:6144
    ds_read_b64_tr_b16 v[196:197], v12 offset:4096
    ds_read_b64_tr_b16 v[198:199], v12 offset:6144
    ds_read_b64_tr_b16 v[200:201], v9 offset:8192
    ds_read_b64_tr_b16 v[202:203], v9 offset:10240
    ds_read_b64_tr_b16 v[204:205], v10 offset:8192
    ds_read_b64_tr_b16 v[206:207], v10 offset:10240
    ds_read_b64_tr_b16 v[208:209], v11 offset:8192
    ds_read_b64_tr_b16 v[210:211], v11 offset:10240
    ds_read_b64_tr_b16 v[212:213], v12 offset:8192
    ds_read_b64_tr_b16 v[214:215], v12 offset:10240
    ds_read_b64_tr_b16 v[216:217], v9 offset:12288
    ds_read_b64_tr_b16 v[218:219], v9 offset:14336
    ds_read_b64_tr_b16 v[220:221], v10 offset:12288
    ds_read_b64_tr_b16 v[222:223], v10 offset:14336
    ds_read_b64_tr_b16 v[224:225], v11 offset:12288
    ds_read_b64_tr_b16 v[226:227], v11 offset:14336
    ds_read_b64_tr_b16 v[228:229], v12 offset:12288
    ds_read_b64_tr_b16 v[230:231], v12 offset:14336
    global_load_dwordx2 v[236:237], v18, s[16:17] offset:0
    global_load_dwordx2 v[238:239], v18, s[16:17] offset:32
    global_load_dwordx2 v[240:241], v19, s[16:17] offset:0
    global_load_dwordx2 v[242:243], v19, s[16:17] offset:32
    s_waitcnt lgkmcnt(0)
    s_add_u32 m0, s13, 0
    s_nop 0
    buffer_load_dwordx4 v232, s[96:99], s101 offen offset:0 lds
    buffer_load_dwordx4 v233, s[96:99], s101 offen offset:1024 lds
    buffer_load_dwordx4 v234, s[96:99], s101 offen offset:2048 lds
    buffer_load_dwordx4 v235, s[96:99], s101 offen offset:3072 lds
    s_add_u32 s101, s101, 0x20000
    s_sub_u32 s101, s101, s61
    s_add_u32 m0, s13, 4096
    s_nop 0
    buffer_load_dwordx4 v232, s[96:99], s101 offen offset:0 lds
    buffer_load_dwordx4 v233, s[96:99], s101 offen offset:1024 lds
    buffer_load_dwordx4 v234, s[96:99], s101 offen offset:2048 lds
    buffer_load_dwordx4 v235, s[96:99], s101 offen offset:3072 lds
    s_add_u32 s101, s101, 0x20000
    s_add_u32 m0, s13, 8192
    s_nop 0
    buffer_load_dwordx4 v232, s[96:99], s101 offen offset:0 lds
    buffer_load_dwordx4 v233, s[96:99], s101 offen offset:1024 lds
    buffer_load_dwordx4 v234, s[96:99], s101 offen offset:2048 lds
    buffer_load_dwordx4 v235, s[96:99], s101 offen offset:3072 lds
    s_add_u32 s101, s101, 0x20000
    s_add_u32 m0, s13, 12288
    s_nop 0
    buffer_load_dwordx4 v232, s[96:99], s101 offen offset:0 lds
    buffer_load_dwordx4 v233, s[96:99], s101 offen offset:1024 lds
    buffer_load_dwordx4 v234, s[96:99], s101 offen offset:2048 lds
    buffer_load_dwordx4 v235, s[96:99], s101 offen offset:3072 lds
    s_add_u32 s101, s101, 0x20000
    s_cmp_lg_u32 s6, 0
    s_cbranch_scc1 L_g2r
    global_load_dword v6, v23, s[44:45] sc1
    global_load_dword v7, v5, s[90:91] sc1
    s_mov_b32 s94, 0
L_g3_p:
    s_waitcnt vmcnt(0)
    v_cmp_ne_u32 vcc, v7, v6
    v_cmp_eq_u32 s[92:93], 0, v6
    s_add_u32 s94, s94, 1
    s_cmp_gt_u32 s94, 0x200000
    s_cbranch_scc1 L_g3_d
    s_or_b64 vcc, vcc, s[92:93]
    s_cbranch_vccz L_g3_d
    s_sleep 2
    global_load_dword v6, v23, s[44:45] sc1
    global_load_dword v7, v5, s[90:91] sc1
    s_branch L_g3_p
L_g3_d:
L_g2r:
    s_waitcnt vmcnt(0)
    s_barrier
    buffer_load_dwordx4 v[88:91], v3, s[48:51], s11 offen sc1
    buffer_load_dwordx4 v[92:95], v3, s[48:51], s57 offen sc1
    buffer_load_dwordx4 v[96:99], v4, s[48:51], s11 offen sc1
    buffer_load_dwordx4 v[100:103], v4, s[48:51], s57 offen sc1
    s_add_u32 s11, s11, 4096
    s_add_u32 s57, s57, 4096
    buffer_load_dwordx4 v[104:107], v3, s[48:51], s11 offen sc1
    buffer_load_dwordx4 v[108:111], v3, s[48:51], s57 offen sc1
    buffer_load_dwordx4 v[112:115], v4, s[48:51], s11 offen sc1
    buffer_load_dwordx4 v[116:119], v4, s[48:51], s57 offen sc1
    s_add_u32 s11, s11, 4096
    s_add_u32 s57, s57, 4096
    buffer_load_dwordx4 v[120:123], v3, s[48:51], s11 offen sc1
    buffer_load_dwordx4 v[124:127], v3, s[48:51], s57 offen sc1
    buffer_load_dwordx4 v[128:131], v4, s[48:51], s11 offen sc1
    buffer_load_dwordx4 v[132:135], v4, s[48:51], s57 offen sc1
    s_add_u32 s11, s11, 4096
    s_add_u32 s57, s57, 4096
    buffer_load_dwordx4 v[136:139], v3, s[48:51], s11 offen sc1
    buffer_load_dwordx4 v[140:143], v3, s[48:51], s57 offen sc1
    buffer_load_dwordx4 v[144:147], v4, s[48:51], s11 offen sc1
    buffer_load_dwordx4 v[148:151], v4, s[48:51], s57 offen sc1
    s_add_u32 s11, s11, 4096
    s_add_u32 s57, s57, 4096
    s_lshl_b32 s64, s15, 2
    s_add_u32 s64, s64, s6
    s_cmp_eq_u32 s64, 7
    s_cselect_b32 s64, 0x7f000000, s11
    s_cselect_b32 s65, 0x7f000000, s57
    buffer_load_dwordx4 v[152:155], v3, s[48:51], s64 offen sc1
    buffer_load_dwordx4 v[156:159], v3, s[48:51], s65 offen sc1
    buffer_load_dwordx4 v[160:163], v4, s[48:51], s64 offen sc1
    buffer_load_dwordx4 v[164:167], v4, s[48:51], s65 offen sc1
    s_add_u32 s11, s11, 4096
    s_add_u32 s57, s57, 4096
    s_sub_u32 s11, s11, s60
    s_sub_u32 s57, s57, s60
    s_waitcnt vmcnt(16) lgkmcnt(0)
    v_mfma_f32_16x16x32_bf16 v[24:27], v[168:171], v[88:91], 0
    v_mfma_f32_16x16x32_bf16 v[28:31], v[172:175], v[88:91], 0
    v_mfma_f32_16x16x32_bf16 v[40:43], v[176:179], v[88:91], 0
    v_mfma_f32_16x16x32_bf16 v[44:47], v[180:183], v[88:91], 0
    buffer_load_dwordx4 v[88:91], v3, s[48:51], s11 offen sc1
    v_mfma_f32_16x16x32_bf16 v[32:35], v[168:171], v[92:95], 0
    v_mfma_f32_16x16x32_bf16 v[36:39], v[172:175], v[92:95], 0
    v_mfma_f32_16x16x32_bf16 v[48:51], v[176:179], v[92:95], 0
    v_mfma_f32_16x16x32_bf16 v[52:55], v[180:183], v[92:95], 0
    buffer_load_dwordx4 v[92:95], v3, s[48:51], s57 offen sc1
    v_mfma_f32_16x16x32_bf16 v[56:59], v[168:171], v[96:99], 0
    v_mfma_f32_16x16x32_bf16 v[60:63], v[172:175], v[96:99], 0
    v_mfma_f32_16x16x32_bf16 v[72:75], v[176:179], v[96:99], 0
    v_mfma_f32_16x16x32_bf16 v[76:79], v[180:183], v[96:99], 0
    buffer_load_dwordx4 v[96:99], v4, s[48:51], s11 offen sc1
    v_mfma_f32_16x16x32_bf16 v[64:67], v[168:171], v[100:103], 0
    v_mfma_f32_16x16x32_bf16 v[68:71], v[172:175], v[100:103], 0
    v_mfma_f32_16x16x32_bf16 v[80:83], v[176:179], v[100:103], 0
    v_mfma_f32_16x16x32_bf16 v[84:87], v[180:183], v[100:103], 0
    buffer_load_dwordx4 v[100:103], v4, s[48:51], s57 offen sc1
    s_add_u32 s11, s11, 4096
    s_add_u32 s57, s57, 4096
    s_waitcnt vmcnt(16) lgkmcnt(0)
    v_mfma_f32_16x16x32_bf16 v[24:27], v[184:187], v[104:107], v[24:27]
    v_mfma_f32_16x16x32_bf16 v[28:31], v[188:191], v[104:107], v[28:31]
    v_mfma_f32_16x16x32_bf16 v[40:43], v[192:195], v[104:107], v[40:43]
    v_mfma_f32_16x16x32_bf16 v[44:47], v[196:199], v[104:107], v[44:47]
    buffer_load_dwordx4 v[104:107], v3, s[48:51], s11 offen sc1
    v_mfma_f32_16x16x32_bf16 v[32:35], v[184:187], v[108:111], v[32:35]
    v_mfma_f32_16x16x32_bf16 v[36:39], v[188:191], v[108:111], v[36:39]
    v_mfma_f32_16x16x32_bf16 v[48:51], v[192:195], v[108:111], v[48:51]
    v_mfma_f32_16x16x32_bf16 v[52:55], v[196:199], v[108:111], v[52:55]
    buffer_load_dwordx4 v[108:111], v3, s[48:51], s57 offen sc1
    v_mfma_f32_16x16x32_bf16 v[56:59], v[184:187], v[112:115], v[56:59]
    v_mfma_f32_16x16x32_bf16 v[60:63], v[188:191], v[112:115], v[60:63]
    v_mfma_f32_16x16x32_bf16 v[72:75], v[192:195], v[112:115], v[72:75]
    v_mfma_f32_16x16x32_bf16 v[76:79], v[196:199], v[112:115], v[76:79]
    buffer_load_dwordx4 v[112:115], v4, s[48:51], s11 offen sc1
    v_mfma_f32_16x16x32_bf16 v[64:67], v[184:187], v[116:119], v[64:67]
    v_mfma_f32_16x16x32_bf16 v[68:71], v[188:191], v[116:119], v[68:71]
    v_mfma_f32_16x16x32_bf16 v[80:83], v[192:195], v[116:119], v[80:83]
    v_mfma_f32_16x16x32_bf16 v[84:87], v[196:199], v[116:119], v[84:87]
    buffer_load_dwordx4 v[116:119], v4, s[48:51], s57 offen sc1
    s_add_u32 s11, s11, 4096
    s_add_u32 s57, s57, 4096
    s_waitcnt vmcnt(16) lgkmcnt(0)
    v_mfma_f32_16x16x32_bf16 v[24:27], v[200:203], v[120:123], v[24:27]
    v_mfma_f32_16x16x32_bf16 v[28:31], v[204:207], v[120:123], v[28:31]
    v_mfma_f32_16x16x32_bf16 v[40:43], v[208:211], v[120:123], v[40:43]
    v_mfma_f32_16x16x32_bf16 v[44:47], v[212:215], v[120:123], v[44:47]
    buffer_load_dwordx4 v[120:123], v3, s[48:51], s11 offen sc1
    v_mfma_f32_16x16x32_bf16 v[32:35], v[200:203], v[124:127], v[32:35]
    v_mfma_f32_16x16x32_bf16 v[36:39], v[204:207], v[124:127], v[36:39]
    v_mfma_f32_16x16x32_bf16 v[48:51], v[208:211], v[124:127], v[48:51]
    v_mfma_f32_16x16x32_bf16 v[52:55], v[212:215], v[124:127], v[52:55]
    buffer_load_dwordx4 v[124:127], v3, s[48:51], s57 offen sc1
    v_mfma_f32_16x16x32_bf16 v[56:59], v[200:203], v[128:131], v[56:59]
    v_mfma_f32_16x16x32_bf16 v[60:63], v[204:207], v[128:131], v[60:63]
    v_mfma_f32_16x16x32_bf16 v[72:75], v[208:211], v[128:131], v[72:75]
    v_mfma_f32_16x16x32_bf16 v[76:79], v[212:215], v[128:131], v[76:79]
    buffer_load_dwordx4 v[128:131], v4, s[48:51], s11 offen sc1
    v_mfma_f32_16x16x32_bf16 v[64:67], v[200:203], v[132:135], v[64:67]
    v_mfma_f32_16x16x32_bf16 v[68:71], v[204:207], v[132:135], v[68:71]
    v_mfma_f32_16x16x32_bf16 v[80:83], v[208:211], v[132:135], v[80:83]
    v_mfma_f32_16x16x32_bf16 v[84:87], v[212:215], v[132:135], v[84:87]
    buffer_load_dwordx4 v[132:135], v4, s[48:51], s57 offen sc1
    s_add_u32 s11, s11, 4096
    s_add_u32 s57, s57, 4096
    s_waitcnt vmcnt(16) lgkmcnt(0)
    v_mfma_f32_16x16x32_bf16 v[24:27], v[216:219], v[136:139], v[24:27]
    ds_read_b64_tr_b16 v[168:169], v9 offset:0
    ds_read_b64_tr_b16 v[170:171], v9 offset:2048
    v_mfma_f32_16x16x32_bf16 v[28:31], v[220:223], v[136:139], v[28:31]
    ds_read_b64_tr_b16 v[172:173], v10 offset:0
    ds_read_b64_tr_b16 v[174:175], v10 offset:2048
    v_mfma_f32_16x16x32_bf16 v[40:43], v[224:227], v[136:139], v[40:43]
    ds_read_b64_tr_b16 v[176:177], v11 offset:0
    ds_read_b64_tr_b16 v[178:179], v11 offset:2048
    v_mfma_f32_16x16x32_bf16 v[44:47], v[228:231], v[136:139], v[44:47]
    ds_read_b64_tr_b16 v[180:181], v12 offset:0
    ds_read_b64_tr_b16 v[182:183], v12 offset:2048
    buffer_load_dwordx4 v[136:139], v3, s[48:51], s11 offen sc1
    v_mfma_f32_16x16x32_bf16 v[32:35], v[216:219], v[140:143], v[32:35]
    v_mfma_f32_16x16x32_bf16 v[36:39], v[220:223], v[140:143], v[36:39]
    v_mfma_f32_16x16x32_bf16 v[48:51], v[224:227], v[140:143], v[48:51]
    v_mfma_f32_16x16x32_bf16 v[52:55], v[228:231], v[140:143], v[52:55]
    buffer_load_dwordx4 v[140:143], v3, s[48:51], s57 offen sc1
    v_mfma_f32_16x16x32_bf16 v[56:59], v[216:219], v[144:147], v[56:59]
    v_mfma_f32_16x16x32_bf16 v[60:63], v[220:223], v[144:147], v[60:63]
    v_mfma_f32_16x16x32_bf16 v[72:75], v[224:227], v[144:147], v[72:75]
    v_mfma_f32_16x16x32_bf16 v[76:79], v[228:231], v[144:147], v[76:79]
    buffer_load_dwordx4 v[144:147], v4, s[48:51], s11 offen sc1
    v_mfma_f32_16x16x32_bf16 v[64:67], v[216:219], v[148:151], v[64:67]
    v_mfma_f32_16x16x32_bf16 v[68:71], v[220:223], v[148:151], v[68:71]
    v_mfma_f32_16x16x32_bf16 v[80:83], v[224:227], v[148:151], v[80:83]
    v_mfma_f32_16x16x32_bf16 v[84:87], v[228:231], v[148:151], v[84:87]
    buffer_load_dwordx4 v[148:151], v4, s[48:51], s57 offen sc1
    s_add_u32 s11, s11, 4096
    s_add_u32 s57, s57, 4096
    s_waitcnt vmcnt(16) lgkmcnt(0)
    v_mfma_f32_16x16x32_bf16 v[24:27], v[168:171], v[152:155], v[24:27]
    s_add_u32 m0, s13, 0
    ds_read_b64_tr_b16 v[184:185], v9 offset:4096
    v_mfma_f32_16x16x32_bf16 v[28:31], v[172:175], v[152:155], v[28:31]
    buffer_load_dwordx4 v232, s[96:99], s101 offen offset:0 lds
    ds_read_b64_tr_b16 v[186:187], v9 offset:6144
    v_mfma_f32_16x16x32_bf16 v[40:43], v[176:179], v[152:155], v[40:43]
    buffer_load_dwordx4 v233, s[96:99], s101 offen offset:1024 lds
    ds_read_b64_tr_b16 v[188:189], v10 offset:4096
    v_mfma_f32_16x16x32_bf16 v[44:47], v[180:183], v[152:155], v[44:47]
    buffer_load_dwordx4 v234, s[96:99], s101 offen offset:2048 lds
    ds_read_b64_tr_b16 v[190:191], v10 offset:6144
    buffer_load_dwordx4 v[152:155], v3, s[48:51], s11 offen sc1
    v_mfma_f32_16x16x32_bf16 v[32:35], v[168:171], v[156:159], v[32:35]
    buffer_load_dwordx4 v235, s[96:99], s101 offen offset:3072 lds
    ds_read_b64_tr_b16 v[192:193], v11 offset:4096
    v_mfma_f32_16x16x32_bf16 v[36:39], v[172:175], v[156:159], v[36:39]
    ds_read_b64_tr_b16 v[194:195], v11 offset:6144
    ds_read_b64_tr_b16 v[196:197], v12 offset:4096
    v_mfma_f32_16x16x32_bf16 v[48:51], v[176:179], v[156:159], v[48:51]
    ds_read_b64_tr_b16 v[198:199], v12 offset:6144
    s_add_u32 s101, s101, 0x20000
    v_mfma_f32_16x16x32_bf16 v[52:55], v[180:183], v[156:159], v[52:55]
    buffer_load_dwordx4 v[156:159], v3, s[48:51], s57 offen sc1
    v_mfma_f32_16x16x32_bf16 v[56:59], v[168:171], v[160:163], v[56:59]
    v_mfma_f32_16x16x32_bf16 v[60:63], v[172:175], v[160:163], v[60:63]
    v_mfma_f32_16x16x32_bf16 v[72:75], v[176:179], v[160:163], v[72:75]
    v_mfma_f32_16x16x32_bf16 v[76:79], v[180:183], v[160:163], v[76:79]
    buffer_load_dwordx4 v[160:163], v4, s[48:51], s11 offen sc1
    v_mfma_f32_16x16x32_bf16 v[64:67], v[168:171], v[164:167], v[64:67]
    v_mfma_f32_16x16x32_bf16 v[68:71], v[172:175], v[164:167], v[68:71]
    v_mfma_f32_16x16x32_bf16 v[80:83], v[176:179], v[164:167], v[80:83]
    v_mfma_f32_16x16x32_bf16 v[84:87], v[180:183], v[164:167], v[84:87]
    buffer_load_dwordx4 v[164:167], v4, s[48:51], s57 offen sc1
    s_add_u32 s11, s11, 4096
    s_add_u32 s57, s57, 4096
    s_waitcnt vmcnt(16) lgkmcnt(0)
    v_mfma_f32_16x16x32_bf16 v[24:27], v[184:187], v[88:91], v[24:27]
    s_add_u32 m0, s13, 4096
    ds_read_b64_tr_b16 v[168:169], v9 offset:8192
    v_mfma_f32_16x16x32_bf16 v[28:31], v[188:191], v[88:91], v[28:31]
    buffer_load_dwordx4 v232, s[96:99], s101 offen offset:0 lds
    ds_read_b64_tr_b16 v[170:171], v9 offset:10240
    v_mfma_f32_16x16x32_bf16 v[40:43], v[192:195], v[88:91], v[40:43]
    buffer_load_dwordx4 v233, s[96:99], s101 offen offset:1024 lds
    ds_read_b64_tr_b16 v[172:173], v10 offset:8192
    v_mfma_f32_16x16x32_bf16 v[44:47], v[196:199], v[88:91], v[44:47]
    buffer_load_dwordx4 v234, s[96:99], s101 offen offset:2048 lds
    ds_read_b64_tr_b16 v[174:175], v10 offset:10240
    s_lshl_b32 s64, s15, 2
    s_add_u32 s64, s64, s6
    s_cmp_eq_u32 s64, 3
    s_cselect_b32 s64, 0x7f000000, s11
    s_cselect_b32 s65, 0x7f000000, s57
    buffer_load_dwordx4 v[88:91], v3, s[48:51], s64 offen sc1
    v_mfma_f32_16x16x32_bf16 v[32:35], v[184:187], v[92:95], v[32:35]
    buffer_load_dwordx4 v235, s[96:99], s101 offen offset:3072 lds
    ds_read_b64_tr_b16 v[176:177], v11 offset:8192
    v_mfma_f32_16x16x32_bf16 v[36:39], v[188:191], v[92:95], v[36:39]
    ds_read_b64_tr_b16 v[178:179], v11 offset:10240
    ds_read_b64_tr_b16 v[180:181], v12 offset:8192
    v_mfma_f32_16x16x32_bf16 v[48:51], v[192:195], v[92:95], v[48:51]
    ds_read_b64_tr_b16 v[182:183], v12 offset:10240
    s_add_u32 s101, s101, 0x20000
    v_mfma_f32_16x16x32_bf16 v[52:55], v[196:199], v[92:95], v[52:55]
    buffer_load_dwordx4 v[92:95], v3, s[48:51], s65 offen sc1
    v_mfma_f32_16x16x32_bf16 v[56:59], v[184:187], v[96:99], v[56:59]
    v_mfma_f32_16x16x32_bf16 v[60:63], v[188:191], v[96:99], v[60:63]
    v_mfma_f32_16x16x32_bf16 v[72:75], v[192:195], v[96:99], v[72:75]
    v_mfma_f32_16x16x32_bf16 v[76:79], v[196:199], v[96:99], v[76:79]
    buffer_load_dwordx4 v[96:99], v4, s[48:51], s64 offen sc1
    v_mfma_f32_16x16x32_bf16 v[64:67], v[184:187], v[100:103], v[64:67]
    v_mfma_f32_16x16x32_bf16 v[68:71], v[188:191], v[100:103], v[68:71]
    v_mfma_f32_16x16x32_bf16 v[80:83], v[192:195], v[100:103], v[80:83]
    v_mfma_f32_16x16x32_bf16 v[84:87], v[196:199], v[100:103], v[84:87]
    buffer_load_dwordx4 v[100:103], v4, s[48:51], s65 offen sc1
    s_add_u32 s11, s11, 4096
    s_add_u32 s57, s57, 4096
    s_waitcnt vmcnt(16) lgkmcnt(0)
    v_mfma_f32_16x16x32_bf16 v[24:27], v[168:171], v[104:107], v[24:27]
    s_add_u32 m0, s13, 8192
    ds_read_b64_tr_b16 v[184:185], v9 offset:12288
    v_mfma_f32_16x16x32_bf16 v[28:31], v[172:175], v[104:107], v[28:31]
    buffer_load_dwordx4 v232, s[96:99], s101 offen offset:0 lds
    ds_read_b64_tr_b16 v[186:187], v9 offset:14336
    v_mfma_f32_16x16x32_bf16 v[40:43], v[176:179], v[104:107], v[40:43]
    buffer_load_dwordx4 v233, s[96:99], s101 offen offset:1024 lds
    ds_read_b64_tr_b16 v[188:189], v10 offset:12288
    v_mfma_f32_16x16x32_bf16 v[44:47], v[180:183], v[104:107], v[44:47]
    buffer_load_dwordx4 v234, s[96:99], s101 offen offset:2048 lds
    ds_read_b64_tr_b16 v[190:191], v10 offset:14336
    v_mfma_f32_16x16x32_bf16 v[32:35], v[168:171], v[108:111], v[32:35]
    buffer_load_dwordx4 v235, s[96:99], s101 offen offset:3072 lds
    ds_read_b64_tr_b16 v[192:193], v11 offset:12288
    v_mfma_f32_16x16x32_bf16 v[36:39], v[172:175], v[108:111], v[36:39]
    ds_read_b64_tr_b16 v[194:195], v11 offset:14336
    ds_read_b64_tr_b16 v[196:197], v12 offset:12288
    v_mfma_f32_16x16x32_bf16 v[48:51], v[176:179], v[108:111], v[48:51]
    ds_read_b64_tr_b16 v[198:199], v12 offset:14336
    s_add_u32 s101, s101, 0x20000
    v_mfma_f32_16x16x32_bf16 v[52:55], v[180:183], v[108:111], v[52:55]
    v_mfma_f32_16x16x32_bf16 v[56:59], v[168:171], v[112:115], v[56:59]
    v_mfma_f32_16x16x32_bf16 v[60:63], v[172:175], v[112:115], v[60:63]
    v_mfma_f32_16x16x32_bf16 v[72:75], v[176:179], v[112:115], v[72:75]
    v_mfma_f32_16x16x32_bf16 v[76:79], v[180:183], v[112:115], v[76:79]
    v_mfma_f32_16x16x32_bf16 v[64:67], v[168:171], v[116:119], v[64:67]
    v_mfma_f32_16x16x32_bf16 v[68:71], v[172:175], v[116:119], v[68:71]
    v_mfma_f32_16x16x32_bf16 v[80:83], v[176:179], v[116:119], v[80:83]
    v_mfma_f32_16x16x32_bf16 v[84:87], v[180:183], v[116:119], v[84:87]
    s_waitcnt vmcnt(8) lgkmcnt(0)
    v_mfma_f32_16x16x32_bf16 v[24:27], v[184:187], v[120:123], v[24:27]
    ds_read_b64_tr_b16 v[168:169], v9 offset:0
    ds_read_b64_tr_b16 v[170:171], v9 offset:2048
    v_mfma_f32_16x16x32_bf16 v[28:31], v[188:191], v[120:123], v[28:31]
    ds_read_b64_tr_b16 v[172:173], v10 offset:0
    ds_read_b64_tr_b16 v[174:175], v10 offset:2048
    v_mfma_f32_16x16x32_bf16 v[40:43], v[192:195], v[120:123], v[40:43]
    ds_read_b64_tr_b16 v[176:177], v11 offset:0
    ds_read_b64_tr_b16 v[178:179], v11 offset:2048
    v_mfma_f32_16x16x32_bf16 v[44:47], v[196:199], v[120:123], v[44:47]
    ds_read_b64_tr_b16 v[180:181], v12 offset:0
    ds_read_b64_tr_b16 v[182:183], v12 offset:2048
    v_mfma_f32_16x16x32_bf16 v[32:35], v[184:187], v[124:127], v[32:35]
    v_mfma_f32_16x16x32_bf16 v[36:39], v[188:191], v[124:127], v[36:39]
    v_mfma_f32_16x16x32_bf16 v[48:51], v[192:195], v[124:127], v[48:51]
    v_mfma_f32_16x16x32_bf16 v[52:55], v[196:199], v[124:127], v[52:55]
    v_mfma_f32_16x16x32_bf16 v[56:59], v[184:187], v[128:131], v[56:59]
    v_mfma_f32_16x16x32_bf16 v[60:63], v[188:191], v[128:131], v[60:63]
    v_mfma_f32_16x16x32_bf16 v[72:75], v[192:195], v[128:131], v[72:75]
    v_mfma_f32_16x16x32_bf16 v[76:79], v[196:199], v[128:131], v[76:79]
    v_mfma_f32_16x16x32_bf16 v[64:67], v[184:187], v[132:135], v[64:67]
    v_mfma_f32_16x16x32_bf16 v[68:71], v[188:191], v[132:135], v[68:71]
    v_mfma_f32_16x16x32_bf16 v[80:83], v[192:195], v[132:135], v[80:83]
    v_mfma_f32_16x16x32_bf16 v[84:87], v[196:199], v[132:135], v[84:87]
    s_waitcnt vmcnt(4) lgkmcnt(0)
    v_mfma_f32_16x16x32_bf16 v[24:27], v[168:171], v[136:139], v[24:27]
    ds_read_b64_tr_b16 v[184:185], v9 offset:4096
    ds_read_b64_tr_b16 v[186:187], v9 offset:6144
    v_mfma_f32_16x16x32_bf16 v[28:31], v[172:175], v[136:139], v[28:31]
    ds_read_b64_tr_b16 v[188:189], v10 offset:4096
    ds_read_b64_tr_b16 v[190:191], v10 offset:6144
    v_mfma_f32_16x16x32_bf16 v[40:43], v[176:179], v[136:139], v[40:43]
    ds_read_b64_tr_b16 v[192:193], v11 offset:4096
    ds_read_b64_tr_b16 v[194:195], v11 offset:6144
    v_mfma_f32_16x16x32_bf16 v[44:47], v[180:183], v[136:139], v[44:47]
    ds_read_b64_tr_b16 v[196:197], v12 offset:4096
    ds_read_b64_tr_b16 v[198:199], v12 offset:6144
    v_mfma_f32_16x16x32_bf16 v[32:35], v[168:171], v[140:143], v[32:35]
    v_mfma_f32_16x16x32_bf16 v[36:39], v[172:175], v[140:143], v[36:39]
    v_mfma_f32_16x16x32_bf16 v[48:51], v[176:179], v[140:143], v[48:51]
    v_mfma_f32_16x16x32_bf16 v[52:55], v[180:183], v[140:143], v[52:55]
    v_mfma_f32_16x16x32_bf16 v[56:59], v[168:171], v[144:147], v[56:59]
    v_mfma_f32_16x16x32_bf16 v[60:63], v[172:175], v[144:147], v[60:63]
    v_mfma_f32_16x16x32_bf16 v[72:75], v[176:179], v[144:147], v[72:75]
    v_mfma_f32_16x16x32_bf16 v[76:79], v[180:183], v[144:147], v[76:79]
    v_mfma_f32_16x16x32_bf16 v[64:67], v[168:171], v[148:151], v[64:67]
    v_mfma_f32_16x16x32_bf16 v[68:71], v[172:175], v[148:151], v[68:71]
    v_mfma_f32_16x16x32_bf16 v[80:83], v[176:179], v[148:151], v[80:83]
    v_mfma_f32_16x16x32_bf16 v[84:87], v[180:183], v[148:151], v[84:87]
    s_waitcnt vmcnt(0) lgkmcnt(0)
    s_add_u32 s56, s46, 13631488
    s_addc_u32 s57, s47, 0
    s_lshl_b32 s3, s8, 9
    s_add_u32 s3, s3, 16384
    v_and_b32 v4, 31, v1
    v_lshl_add_u32 v5, v4, 4, s3
    global_load_dword v8, v23, s[44:45] sc1
    global_load_dword v22, v5, s[90:91] sc1
    s_lshl_b32 s3, s8, 6
    s_lshl_b32 s14, s9, 5
    s_add_u32 s3, s3, s14
    s_lshl_b32 s3, s3, 12
    s_lshl_b32 s14, s7, 7
    s_add_u32 s3, s3, s14
    s_lshl_b32 s14, s10, 6
    s_add_u32 s3, s3, s14
    v_lshlrev_b32 v6, 12, v13
    v_lshl_add_u32 v6, v14, 4, v6
    v_add_u32 v6, s3, v6
    v_add_u32 v7, 0x10000, v6
    v_mfma_f32_16x16x32_bf16 v[24:27], v[184:187], v[152:155], v[24:27]
    ds_read_b64_tr_b16 v[168:169], v9 offset:8192
    ds_read_b64_tr_b16 v[170:171], v9 offset:10240
    v_mfma_f32_16x16x32_bf16 v[28:31], v[188:191], v[152:155], v[28:31]
    ds_read_b64_tr_b16 v[172:173], v10 offset:8192
    ds_read_b64_tr_b16 v[174:175], v10 offset:10240
    v_mfma_f32_16x16x32_bf16 v[40:43], v[192:195], v[152:155], v[40:43]
    ds_read_b64_tr_b16 v[176:177], v11 offset:8192
    ds_read_b64_tr_b16 v[178:179], v11 offset:10240
    v_mfma_f32_16x16x32_bf16 v[44:47], v[196:199], v[152:155], v[44:47]
    ds_read_b64_tr_b16 v[180:181], v12 offset:8192
    ds_read_b64_tr_b16 v[182:183], v12 offset:10240
    v_mfma_f32_16x16x32_bf16 v[32:35], v[184:187], v[156:159], v[32:35]
    v_mfma_f32_16x16x32_bf16 v[36:39], v[188:191], v[156:159], v[36:39]
    v_mfma_f32_16x16x32_bf16 v[48:51], v[192:195], v[156:159], v[48:51]
    v_mfma_f32_16x16x32_bf16 v[52:55], v[196:199], v[156:159], v[52:55]
    v_mfma_f32_16x16x32_bf16 v[56:59], v[184:187], v[160:163], v[56:59]
    v_mfma_f32_16x16x32_bf16 v[60:63], v[188:191], v[160:163], v[60:63]
    v_mfma_f32_16x16x32_bf16 v[72:75], v[192:195], v[160:163], v[72:75]
    v_mfma_f32_16x16x32_bf16 v[76:79], v[196:199], v[160:163], v[76:79]
    v_mfma_f32_16x16x32_bf16 v[64:67], v[184:187], v[164:167], v[64:67]
    v_mfma_f32_16x16x32_bf16 v[68:71], v[188:191], v[164:167], v[68:71]
    v_mfma_f32_16x16x32_bf16 v[80:83], v[192:195], v[164:167], v[80:83]
    v_mfma_f32_16x16x32_bf16 v[84:87], v[196:199], v[164:167], v[84:87]
    s_waitcnt lgkmcnt(0)
    s_mov_b32 s94, 0
L_g4_p:
    s_waitcnt vmcnt(0)
    v_cmp_ne_u32 vcc, v22, v8
    v_cmp_eq_u32 s[92:93], 0, v8
    s_add_u32 s94, s94, 1
    s_cmp_gt_u32 s94, 0x200000
    s_cbranch_scc1 L_g4_d
    s_or_b64 vcc, vcc, s[92:93]
    s_cbranch_vccz L_g4_d
    s_sleep 8
    global_load_dword v8, v23, s[44:45] sc1
    global_load_dword v22, v5, s[90:91] sc1
    s_branch L_g4_p
L_g4_d:
    global_load_dwordx4 v[104:107], v6, s[56:57] sc1
    global_load_dwordx4 v[108:111], v7, s[56:57] sc1
    v_mfma_f32_16x16x32_bf16 v[24:27], v[168:171], v[88:91], v[24:27]
    v_mfma_f32_16x16x32_bf16 v[28:31], v[172:175], v[88:91], v[28:31]
    v_mfma_f32_16x16x32_bf16 v[40:43], v[176:179], v[88:91], v[40:43]
    v_mfma_f32_16x16x32_bf16 v[44:47], v[180:183], v[88:91], v[44:47]
    v_mfma_f32_16x16x32_bf16 v[32:35], v[168:171], v[92:95], v[32:35]
    v_mfma_f32_16x16x32_bf16 v[36:39], v[172:175], v[92:95], v[36:39]
    v_mfma_f32_16x16x32_bf16 v[48:51], v[176:179], v[92:95], v[48:51]
    v_mfma_f32_16x16x32_bf16 v[52:55], v[180:183], v[92:95], v[52:55]
    v_mfma_f32_16x16x32_bf16 v[56:59], v[168:171], v[96:99], v[56:59]
    v_mfma_f32_16x16x32_bf16 v[60:63], v[172:175], v[96:99], v[60:63]
    v_mfma_f32_16x16x32_bf16 v[72:75], v[176:179], v[96:99], v[72:75]
    v_mfma_f32_16x16x32_bf16 v[76:79], v[180:183], v[96:99], v[76:79]
    v_mfma_f32_16x16x32_bf16 v[64:67], v[168:171], v[100:103], v[64:67]
    v_mfma_f32_16x16x32_bf16 v[68:71], v[172:175], v[100:103], v[68:71]
    v_mfma_f32_16x16x32_bf16 v[80:83], v[176:179], v[100:103], v[80:83]
    v_mfma_f32_16x16x32_bf16 v[84:87], v[180:183], v[100:103], v[84:87]
    v_add_u32 v22, s13, v2
    s_nop 7
    ds_write_b128 v22, v[40:43] offset:0
    ds_write_b128 v22, v[44:47] offset:1024
    ds_write_b128 v22, v[48:51] offset:2048
    ds_write_b128 v22, v[52:55] offset:3072
    ds_write_b128 v22, v[56:59] offset:4096
    ds_write_b128 v22, v[60:63] offset:5120
    ds_write_b128 v22, v[64:67] offset:6144
    ds_write_b128 v22, v[68:71] offset:7168
    ds_write_b128 v22, v[72:75] offset:8192
    ds_write_b128 v22, v[76:79] offset:9216
    ds_write_b128 v22, v[80:83] offset:10240
    ds_write_b128 v22, v[84:87] offset:11264
    s_add_u32 s3, s13, 12288
    v_add_u32 v3, s3, v2
    v_lshlrev_b32 v8, 6, v13
    v_lshl_add_u32 v8, v14, 3, v8
    v_add_u32 v8, s3, v8
    v_and_b32 v20, 1, v16
    v_lshl_add_u32 v20, v20, 5, v17
    v_lshrrev_b32 v21, 1, v16
    v_lshl_add_u32 v20, v21, 4, v20
    v_add_u32 v20, s62, v20
    v_add_u32 v21, 0x4000, v20
    s_xor_b32 s3, s6, 1
    s_lshl_b32 s3, s3, 14
    v_add_u32 v10, s3, v2
    s_xor_b32 s3, s6, 2
    s_lshl_b32 s3, s3, 14
    v_add_u32 v11, s3, v2
    s_xor_b32 s3, s6, 3
    s_lshl_b32 s3, s3, 14
    v_add_u32 v12, s3, v2
    v_lshlrev_b32 v200, 16, v236
    v_and_b32 v201, 0xffff0000, v236
    v_lshlrev_b32 v202, 16, v237
    v_and_b32 v203, 0xffff0000, v237
    v_lshlrev_b32 v204, 16, v238
    v_and_b32 v205, 0xffff0000, v238
    v_lshlrev_b32 v206, 16, v239
    v_and_b32 v207, 0xffff0000, v239
    v_lshlrev_b32 v208, 16, v240
    v_and_b32 v209, 0xffff0000, v240
    v_lshlrev_b32 v210, 16, v241
    v_and_b32 v211, 0xffff0000, v241
    v_lshlrev_b32 v212, 16, v242
    v_and_b32 v213, 0xffff0000, v242
    v_lshlrev_b32 v214, 16, v243
    v_and_b32 v215, 0xffff0000, v243
    s_waitcnt lgkmcnt(0)
    s_barrier
    ds_read_b128 v[120:123], v10 offset:0
    ds_read_b128 v[124:127], v10 offset:1024
    ds_read_b128 v[128:131], v10 offset:2048
    ds_read_b128 v[132:135], v10 offset:3072
    ds_read_b128 v[136:139], v11 offset:4096
    ds_read_b128 v[140:143], v11 offset:5120
    ds_read_b128 v[144:147], v11 offset:6144
    ds_read_b128 v[148:151], v11 offset:7168
    ds_read_b128 v[152:155], v12 offset:8192
    ds_read_b128 v[156:159], v12 offset:9216
    ds_read_b128 v[160:163], v12 offset:10240
    ds_read_b128 v[164:167], v12 offset:11264
    s_waitcnt vmcnt(0)
    ds_write_b128 v3, v[104:107]
    ds_write_b128 v3, v[108:111] offset:1024
    s_waitcnt lgkmcnt(6)
    v_add_f32 v24, v24, v120
    v_add_f32 v25, v25, v121
    v_add_f32 v26, v26, v122
    v_add_f32 v27, v27, v123
    v_add_f32 v28, v28, v124
    v_add_f32 v29, v29, v125
    v_add_f32 v30, v30, v126
    v_add_f32 v31, v31, v127
    v_add_f32 v32, v32, v128
    v_add_f32 v33, v33, v129
    v_add_f32 v34, v34, v130
    v_add_f32 v35, v35, v131
    v_add_f32 v36, v36, v132
    v_add_f32 v37, v37, v133
    v_add_f32 v38, v38, v134
    v_add_f32 v39, v39, v135
    s_waitcnt lgkmcnt(0)
    ds_read_b64_tr_b16 v[112:113], v8 offset:0
    ds_read_b64_tr_b16 v[114:115], v8 offset:1024
    ds_read_b64_tr_b16 v[116:117], v8 offset:32
    ds_read_b64_tr_b16 v[118:119], v8 offset:1056
    v_add_f32 v24, v24, v136
    v_add_f32 v25, v25, v137
    v_add_f32 v26, v26, v138
    v_add_f32 v27, v27, v139
    v_add_f32 v28, v28, v140
    v_add_f32 v29, v29, v141
    v_add_f32 v30, v30, v142
    v_add_f32 v31, v31, v143
    v_add_f32 v32, v32, v144
    v_add_f32 v33, v33, v145
    v_add_f32 v34, v34, v146
    v_add_f32 v35, v35, v147
    v_add_f32 v36, v36, v148
    v_add_f32 v37, v37, v149
    v_add_f32 v38, v38, v150
    v_add_f32 v39, v39, v151
    v_add_f32 v24, v24, v152
    v_add_f32 v25, v25, v153
    v_add_f32 v26, v26, v154
    v_add_f32 v27, v27, v155
    v_add_f32 v28, v28, v156
    v_add_f32 v29, v29, v157
    v_add_f32 v30, v30, v158
    v_add_f32 v31, v31, v159
    v_add_f32 v32, v32, v160
    v_add_f32 v33, v33, v161
    v_add_f32 v34, v34, v162
    v_add_f32 v35, v35, v163
    v_add_f32 v36, v36, v164
    v_add_f32 v37, v37, v165
    v_add_f32 v38, v38, v166
    v_add_f32 v39, v39, v167
    s_waitcnt lgkmcnt(2)
    v_lshlrev_b32 v120, 16, v112
    v_and_b32 v121, 0xffff0000, v112
    v_lshlrev_b32 v122, 16, v113
    v_and_b32 v123, 0xffff0000, v113
    v_add_f32 v120, v120, v200
    v_add_f32 v121, v121, v201
    v_add_f32 v122, v122, v202
    v_add_f32 v123, v123, v203
    v_cvt_pk_bf16_f32 v112, v120, v121
    v_cvt_pk_bf16_f32 v113, v122, v123
    v_lshlrev_b32 v120, 16, v112
    v_and_b32 v121, 0xffff0000, v112
    v_lshlrev_b32 v122, 16, v113
    v_and_b32 v123, 0xffff0000, v113
    v_add_f32 v120, v120, v24
    v_add_f32 v121, v121, v25
    v_add_f32 v122, v122, v26
    v_add_f32 v123, v123, v27
    v_lshlrev_b32 v124, 16, v114
    v_and_b32 v125, 0xffff0000, v114
    v_lshlrev_b32 v126, 16, v115
    v_and_b32 v127, 0xffff0000, v115
    v_add_f32 v124, v124, v204
    v_add_f32 v125, v125, v205
    v_add_f32 v126, v126, v206
    v_add_f32 v127, v127, v207
    v_cvt_pk_bf16_f32 v114, v124, v125
    v_cvt_pk_bf16_f32 v115, v126, v127
    v_lshlrev_b32 v124, 16, v114
    v_and_b32 v125, 0xffff0000, v114
    v_lshlrev_b32 v126, 16, v115
    v_and_b32 v127, 0xffff0000, v115
    v_add_f32 v124, v124, v28
    v_add_f32 v125, v125, v29
    v_add_f32 v126, v126, v30
    v_add_f32 v127, v127, v31
    v_cvt_pk_bf16_f32 v128, v120, v121
    v_cvt_pk_bf16_f32 v129, v122, v123
    v_cvt_pk_bf16_f32 v130, v124, v125
    v_cvt_pk_bf16_f32 v131, v126, v127
    s_nop 1
    v_permlane16_swap_b32 v128, v130
    v_permlane16_swap_b32 v129, v131
    s_nop 0
    global_store_dwordx4 v20, v[128:131], s[42:43]
    s_waitcnt lgkmcnt(0)
    v_lshlrev_b32 v136, 16, v116
    v_and_b32 v137, 0xffff0000, v116
    v_lshlrev_b32 v138, 16, v117
    v_and_b32 v139, 0xffff0000, v117
    v_add_f32 v136, v136, v208
    v_add_f32 v137, v137, v209
    v_add_f32 v138, v138, v210
    v_add_f32 v139, v139, v211
    v_cvt_pk_bf16_f32 v116, v136, v137
    v_cvt_pk_bf16_f32 v117, v138, v139
    v_lshlrev_b32 v136, 16, v116
    v_and_b32 v137, 0xffff0000, v116
    v_lshlrev_b32 v138, 16, v117
    v_and_b32 v139, 0xffff0000, v117
    v_add_f32 v136, v136, v32
    v_add_f32 v137, v137, v33
    v_add_f32 v138, v138, v34
    v_add_f32 v139, v139, v35
    v_lshlrev_b32 v140, 16, v118
    v_and_b32 v141, 0xffff0000, v118
    v_lshlrev_b32 v142, 16, v119
    v_and_b32 v143, 0xffff0000, v119
    v_add_f32 v140, v140, v212
    v_add_f32 v141, v141, v213
    v_add_f32 v142, v142, v214
    v_add_f32 v143, v143, v215
    v_cvt_pk_bf16_f32 v118, v140, v141
    v_cvt_pk_bf16_f32 v119, v142, v143
    v_lshlrev_b32 v140, 16, v118
    v_and_b32 v141, 0xffff0000, v118
    v_lshlrev_b32 v142, 16, v119
    v_and_b32 v143, 0xffff0000, v119
    v_add_f32 v140, v140, v36
    v_add_f32 v141, v141, v37
    v_add_f32 v142, v142, v38
    v_add_f32 v143, v143, v39
    v_cvt_pk_bf16_f32 v144, v136, v137
    v_cvt_pk_bf16_f32 v145, v138, v139
    v_cvt_pk_bf16_f32 v146, v140, v141
    v_cvt_pk_bf16_f32 v147, v142, v143
    s_nop 1
    v_permlane16_swap_b32 v144, v146
    v_permlane16_swap_b32 v145, v147
    s_nop 0
    global_store_dwordx4 v21, v[144:147], s[42:43]
L_end4:
    s_endpgm
L_prep:
    s_cmp_ge_u32 s2, 512
    s_cbranch_scc1 L_end3
    s_memrealtime s[64:65]
    s_sub_u32 s3, s2, 256
    v_lshrrev_b32 v2, 6, v0
    v_and_b32 v1, 63, v0
    s_and_b32 s4, s3, 7
    v_readfirstlane_b32 s6, v2
    s_lshr_b32 s5, s3, 3
    s_nop 2
    s_and_b32 s10, s4, 1
    s_lshl_b32 s3, s10, 5
    s_add_u32 s3, s3, s5
    s_and_b32 s12, s3, 3
    s_lshr_b32 s3, s3, 2
    s_lshr_b32 s11, s4, 1
    s_lshl_b32 s11, s11, 4
    s_add_u32 s11, s11, s3
    s_lshl_b32 s3, s11, 15
    s_lshl_b32 s13, s6, 13
    s_add_u32 s3, s3, s13
    s_lshl_b32 s13, s12, 8
    s_add_u32 s3, s3, s13
    v_lshrrev_b32 v17, 3, v1
    v_and_b32 v18, 7, v1
    v_lshlrev_b32 v4, 10, v17
    v_lshl_add_u32 v4, v18, 4, v4
    v_add_u32 v4, s3, v4
    v_xor_b32 v5, 0x100, v4
    v_xor_b32 v6, 0x200, v4
    v_xor_b32 v7, 0x300, v4
    s_waitcnt lgkmcnt(0)
    s_cmp_lg_u32 s2, 256
    s_cbranch_scc1 L_nn
    s_or_b32 s64, s64, 1
    v_mov_b32 v224, s64
    v_mov_b32 v225, 0
    v_cmp_eq_u32 vcc, 0, v0
    s_and_saveexec_b64 s[58:59], vcc
    s_cbranch_execz L_nn2
    global_store_dword v225, v224, s[44:45] sc1
L_nn2:
    s_mov_b64 exec, s[58:59]
    s_waitcnt vmcnt(0)
L_nn:
    global_load_dwordx4 v[100:103], v4, s[16:17] offset:0
    global_load_dwordx4 v[104:107], v4, s[16:17] offset:128
    global_load_dwordx4 v[108:111], v5, s[16:17] offset:0
    global_load_dwordx4 v[112:115], v5, s[16:17] offset:128
    global_load_dwordx4 v[116:119], v6, s[16:17] offset:0
    global_load_dwordx4 v[120:123], v6, s[16:17] offset:128
    global_load_dwordx4 v[124:127], v7, s[16:17] offset:0
    global_load_dwordx4 v[128:131], v7, s[16:17] offset:128
    v_bfe_u32 v80, v1, 2, 2
    v_lshrrev_b32 v81, 5, v1
    v_lshl_add_u32 v80, v81, 3, v80
    v_mul_u32_u24 v80, 320, v80
    v_bfe_u32 v82, v1, 4, 1
    v_lshl_add_u32 v80, v82, 5, v80
    v_and_b32 v83, 3, v1
    v_lshl_add_u32 v80, v83, 3, v80
    s_lshl_b32 s3, s6, 6
    s_add_u32 s3, s3, 68640
    v_add_u32 v80, s3, v80
    s_add_u32 s56, s46, 6291456
    s_addc_u32 s57, s47, 0
    s_lshl_b32 s3, s12, 19
    s_lshl_b32 s13, s6, 17
    s_add_u32 s3, s3, s13
    s_lshl_b32 s13, s11, 6
    s_add_u32 s3, s3, s13
    v_and_b32 v92, 31, v1
    v_lshlrev_b32 v92, 12, v92
    v_lshl_add_u32 v92, v81, 4, v92
    v_add_u32 v92, s3, v92
    s_lshr_b32 s7, s6, 1
    s_and_b32 s8, s6, 1
    s_lshl_b32 s9, s4, 6
    s_lshl_b32 s3, s5, 1
    s_add_u32 s9, s9, s3
    s_add_u32 s9, s9, s7
    s_lshl_b32 s3, s9, 8
    s_lshl_b32 s13, s8, 7
    s_add_u32 s3, s3, s13
    v_lshl_add_u32 v2, v1, 1, s3
    s_lshl_b32 s3, s9, 1
    v_mov_b32 v3, s3
    v_mov_b32 v226, 0
    v_mov_b32 v225, 0
    v_mov_b32 v10, 0
    v_mov_b32 v11, 0
    v_mov_b32 v12, 0
    v_mov_b32 v13, 0
    v_mov_b32 v14, 0
    v_mov_b32 v15, 0
    v_mov_b32 v16, 0
    global_load_short_d16_hi v16, v3, s[30:31]
    global_load_short_d16_hi v10, v2, s[18:19]
    global_load_short_d16_hi v11, v2, s[20:21]
    global_load_short_d16_hi v12, v2, s[22:23]
    global_load_short_d16_hi v13, v2, s[24:25]
    global_load_short_d16_hi v14, v2, s[26:27]
    global_load_short_d16_hi v15, v2, s[28:29]
    global_load_short_d16_hi v226, v3, s[32:33]
    s_add_u32 s90, s46, 15990784
    s_addc_u32 s91, s47, 0
    s_mov_b32 s52, s40
    s_mov_b32 s53, s41
    s_mov_b32 s54, 1409024
    s_mov_b32 s55, 0x00020000
    s_mul_i32 s70, s5, 43
    s_lshl_b32 s70, s70, 10
    s_lshl_b32 s13, s10, 9
    s_add_u32 s70, s70, s13
    s_mul_i32 s13, s6, 11264
    s_add_u32 s70, s70, s13
    s_lshr_b32 s71, s4, 1
    s_add_u32 s71, s71, s6
    s_and_b32 s71, s71, 3
    v_min_u32 v228, 43, v1
    v_lshrrev_b32 v229, 2, v228
    v_lshlrev_b32 v229, 10, v229
    v_and_b32 v228, 3, v228
    v_lshl_add_u32 v228, v228, 7, v229
    s_waitcnt vmcnt(15)
    v_lshlrev_b32 v40, 16, v100
    v_and_b32 v41, 0xffff0000, v100
    v_mov_b32 v20, v40
    v_mul_f32 v21, v40, v40
    v_mov_b32 v22, v41
    v_mul_f32 v23, v41, v41
    v_lshlrev_b32 v42, 16, v101
    v_and_b32 v43, 0xffff0000, v101
    v_add_f32 v20, v20, v42
    v_fmac_f32 v21, v42, v42
    v_add_f32 v22, v22, v43
    v_fmac_f32 v23, v43, v43
    v_lshlrev_b32 v44, 16, v102
    v_and_b32 v45, 0xffff0000, v102
    v_add_f32 v20, v20, v44
    v_fmac_f32 v21, v44, v44
    v_add_f32 v22, v22, v45
    v_fmac_f32 v23, v45, v45
    v_lshlrev_b32 v46, 16, v103
    v_and_b32 v47, 0xffff0000, v103
    v_add_f32 v20, v20, v46
    v_fmac_f32 v21, v46, v46
    v_add_f32 v22, v22, v47
    v_fmac_f32 v23, v47, v47
    s_waitcnt vmcnt(14)
    v_lshlrev_b32 v48, 16, v104
    v_and_b32 v49, 0xffff0000, v104
    v_add_f32 v20, v20, v48
    v_fmac_f32 v21, v48, v48
    v_add_f32 v22, v22, v49
    v_fmac_f32 v23, v49, v49
    v_lshlrev_b32 v50, 16, v105
    v_and_b32 v51, 0xffff0000, v105
    v_add_f32 v20, v20, v50
    v_fmac_f32 v21, v50, v50
    v_add_f32 v22, v22, v51
    v_fmac_f32 v23, v51, v51
    v_lshlrev_b32 v52, 16, v106
    v_and_b32 v53, 0xffff0000, v106
    v_add_f32 v20, v20, v52
    v_fmac_f32 v21, v52, v52
    v_add_f32 v22, v22, v53
    v_fmac_f32 v23, v53, v53
    v_lshlrev_b32 v54, 16, v107
    v_and_b32 v55, 0xffff0000, v107
    v_add_f32 v20, v20, v54
    v_fmac_f32 v21, v54, v54
    v_add_f32 v22, v22, v55
    v_fmac_f32 v23, v55, v55
    s_waitcnt vmcnt(13)
    v_lshlrev_b32 v56, 16, v108
    v_and_b32 v57, 0xffff0000, v108
    v_add_f32 v20, v20, v56
    v_fmac_f32 v21, v56, v56
    v_add_f32 v22, v22, v57
    v_fmac_f32 v23, v57, v57
    v_lshlrev_b32 v58, 16, v109
    v_and_b32 v59, 0xffff0000, v109
    v_add_f32 v20, v20, v58
    v_fmac_f32 v21, v58, v58
    v_add_f32 v22, v22, v59
    v_fmac_f32 v23, v59, v59
    v_lshlrev_b32 v56, 16, v110
    v_and_b32 v57, 0xffff0000, v110
    v_add_f32 v20, v20, v56
    v_fmac_f32 v21, v56, v56
    v_add_f32 v22, v22, v57
    v_fmac_f32 v23, v57, v57
    v_lshlrev_b32 v58, 16, v111
    v_and_b32 v59, 0xffff0000, v111
    v_add_f32 v20, v20, v58
    v_fmac_f32 v21, v58, v58
    v_add_f32 v22, v22, v59
    v_fmac_f32 v23, v59, v59
    s_waitcnt vmcnt(12)
    v_lshlrev_b32 v56, 16, v112
    v_and_b32 v57, 0xffff0000, v112
    v_add_f32 v20, v20, v56
    v_fmac_f32 v21, v56, v56
    v_add_f32 v22, v22, v57
    v_fmac_f32 v23, v57, v57
    v_lshlrev_b32 v58, 16, v113
    v_and_b32 v59, 0xffff0000, v113
    v_add_f32 v20, v20, v58
    v_fmac_f32 v21, v58, v58
    v_add_f32 v22, v22, v59
    v_fmac_f32 v23, v59, v59
    v_lshlrev_b32 v56, 16, v114
    v_and_b32 v57, 0xffff0000, v114
    v_add_f32 v20, v20, v56
    v_fmac_f32 v21, v56, v56
    v_add_f32 v22, v22, v57
    v_fmac_f32 v23, v57, v57
    v_lshlrev_b32 v58, 16, v115
    v_and_b32 v59, 0xffff0000, v115
    v_add_f32 v20, v20, v58
    v_fmac_f32 v21, v58, v58
    v_add_f32 v22, v22, v59
    v_fmac_f32 v23, v59, v59
    s_waitcnt vmcnt(11)
    v_lshlrev_b32 v56, 16, v116
    v_and_b32 v57, 0xffff0000, v116
    v_add_f32 v20, v20, v56
    v_fmac_f32 v21, v56, v56
    v_add_f32 v22, v22, v57
    v_fmac_f32 v23, v57, v57
    v_lshlrev_b32 v58, 16, v117
    v_and_b32 v59, 0xffff0000, v117
    v_add_f32 v20, v20, v58
    v_fmac_f32 v21, v58, v58
    v_add_f32 v22, v22, v59
    v_fmac_f32 v23, v59, v59
    v_lshlrev_b32 v56, 16, v118
    v_and_b32 v57, 0xffff0000, v118
    v_add_f32 v20, v20, v56
    v_fmac_f32 v21, v56, v56
    v_add_f32 v22, v22, v57
    v_fmac_f32 v23, v57, v57
    v_lshlrev_b32 v58, 16, v119
    v_and_b32 v59, 0xffff0000, v119
    v_add_f32 v20, v20, v58
    v_fmac_f32 v21, v58, v58
    v_add_f32 v22, v22, v59
    v_fmac_f32 v23, v59, v59
    s_waitcnt vmcnt(10)
    v_lshlrev_b32 v56, 16, v120
    v_and_b32 v57, 0xffff0000, v120
    v_add_f32 v20, v20, v56
    v_fmac_f32 v21, v56, v56
    v_add_f32 v22, v22, v57
    v_fmac_f32 v23, v57, v57
    v_lshlrev_b32 v58, 16, v121
    v_and_b32 v59, 0xffff0000, v121
    v_add_f32 v20, v20, v58
    v_fmac_f32 v21, v58, v58
    v_add_f32 v22, v22, v59
    v_fmac_f32 v23, v59, v59
    v_lshlrev_b32 v56, 16, v122
    v_and_b32 v57, 0xffff0000, v122
    v_add_f32 v20, v20, v56
    v_fmac_f32 v21, v56, v56
    v_add_f32 v22, v22, v57
    v_fmac_f32 v23, v57, v57
    v_lshlrev_b32 v58, 16, v123
    v_and_b32 v59, 0xffff0000, v123
    v_add_f32 v20, v20, v58
    v_fmac_f32 v21, v58, v58
    v_add_f32 v22, v22, v59
    v_fmac_f32 v23, v59, v59
    s_waitcnt vmcnt(9)
    v_lshlrev_b32 v56, 16, v124
    v_and_b32 v57, 0xffff0000, v124
    v_add_f32 v20, v20, v56
    v_fmac_f32 v21, v56, v56
    v_add_f32 v22, v22, v57
    v_fmac_f32 v23, v57, v57
    v_lshlrev_b32 v58, 16, v125
    v_and_b32 v59, 0xffff0000, v125
    v_add_f32 v20, v20, v58
    v_fmac_f32 v21, v58, v58
    v_add_f32 v22, v22, v59
    v_fmac_f32 v23, v59, v59
    v_lshlrev_b32 v56, 16, v126
    v_and_b32 v57, 0xffff0000, v126
    v_add_f32 v20, v20, v56
    v_fmac_f32 v21, v56, v56
    v_add_f32 v22, v22, v57
    v_fmac_f32 v23, v57, v57
    v_lshlrev_b32 v58, 16, v127
    v_and_b32 v59, 0xffff0000, v127
    v_add_f32 v20, v20, v58
    v_fmac_f32 v21, v58, v58
    v_add_f32 v22, v22, v59
    v_fmac_f32 v23, v59, v59
    s_waitcnt vmcnt(8)
    v_lshlrev_b32 v56, 16, v128
    v_and_b32 v57, 0xffff0000, v128
    v_add_f32 v20, v20, v56
    v_fmac_f32 v21, v56, v56
    v_add_f32 v22, v22, v57
    v_fmac_f32 v23, v57, v57
    v_lshlrev_b32 v58, 16, v129
    v_and_b32 v59, 0xffff0000, v129
    v_add_f32 v20, v20, v58
    v_fmac_f32 v21, v58, v58
    v_add_f32 v22, v22, v59
    v_fmac_f32 v23, v59, v59
    v_lshlrev_b32 v56, 16, v130
    v_and_b32 v57, 0xffff0000, v130
    v_add_f32 v20, v20, v56
    v_fmac_f32 v21, v56, v56
    v_add_f32 v22, v22, v57
    v_fmac_f32 v23, v57, v57
    v_lshlrev_b32 v58, 16, v131
    v_and_b32 v59, 0xffff0000, v131
    v_add_f32 v20, v20, v58
    v_fmac_f32 v21, v58, v58
    v_add_f32 v22, v22, v59
    v_fmac_f32 v23, v59, v59
    v_add_f32 v20, v20, v22
    v_add_f32 v21, v21, v23
    s_nop 0
    s_nop 0
    v_add_f32_dpp v20, v20, v20 quad_perm:[1,0,3,2] row_mask:0xf bank_mask:0xf
    v_add_f32_dpp v21, v21, v21 quad_perm:[1,0,3,2] row_mask:0xf bank_mask:0xf
    s_nop 0
    v_add_f32_dpp v20, v20, v20 quad_perm:[2,3,0,1] row_mask:0xf bank_mask:0xf
    v_add_f32_dpp v21, v21, v21 quad_perm:[2,3,0,1] row_mask:0xf bank_mask:0xf
    s_nop 0
    v_add_f32_dpp v20, v20, v20 row_half_mirror row_mask:0xf bank_mask:0xf
    v_add_f32_dpp v21, v21, v21 row_half_mirror row_mask:0xf bank_mask:0xf
    v_mul_f32 v20, 0x3b000000, v20
    v_mul_f32 v21, 0x3b000000, v21
    v_fma_f32 v21, -v20, v20, v21
    v_max_f32 v21, 0, v21
    v_cvt_pk_bf16_f32 v20, v20, v21
    v_and_b32 v21, 0xffff0000, v20
    v_lshlrev_b32 v20, 16, v20
    v_add_f32 v21, 0x3727c5ac, v21
    v_cvt_pk_bf16_f32 v21, v21, v21
    v_and_b32 v21, 0xffff0000, v21
    v_sqrt_f32 v21, v21
    v_sub_f32 v40, v40, v20
    v_sub_f32 v41, v41, v20
    v_sub_f32 v42, v42, v20
    v_sub_f32 v43, v43, v20
    v_sub_f32 v44, v44, v20
    v_sub_f32 v45, v45, v20
    v_sub_f32 v46, v46, v20
    v_sub_f32 v47, v47, v20
    v_sub_f32 v48, v48, v20
    v_sub_f32 v49, v49, v20
    v_sub_f32 v50, v50, v20
    v_sub_f32 v51, v51, v20
    v_sub_f32 v52, v52, v20
    v_sub_f32 v53, v53, v20
    v_sub_f32 v54, v54, v20
    v_sub_f32 v55, v55, v20
    v_cvt_pk_bf16_f32 v21, v21, v21
    v_and_b32 v21, 0xffff0000, v21
    v_mul_f32 v26, v21, v21
    v_rcp_f32 v21, v21
    v_sub_f32 v24, 0, v20
    v_log_f32 v27, v26
    v_mul_f32 v25, 0xbfb8aa3b, v21
    s_add_u32 s58, s46, 15859712
    s_addc_u32 s59, s47, 0
    s_lshl_b32 s3, s11, 9
    s_lshl_b32 s13, s6, 7
    s_add_u32 s3, s3, s13
    v_lshl_add_u32 v28, v17, 4, s3
    s_cmp_lg_u32 s12, 0
    s_cbranch_scc1 L_pns
    global_store_dwordx4 v28, v[24:27], s[58:59] sc1
L_pns:
    v_cvt_pk_bf16_f32 v60, v40, v41
    v_cvt_pk_bf16_f32 v61, v42, v43
    v_cvt_pk_bf16_f32 v62, v44, v45
    v_cvt_pk_bf16_f32 v63, v46, v47
    v_cvt_pk_bf16_f32 v64, v48, v49
    v_cvt_pk_bf16_f32 v65, v50, v51
    v_cvt_pk_bf16_f32 v66, v52, v53
    v_cvt_pk_bf16_f32 v67, v54, v55
    v_lshlrev_b32 v40, 16, v60
    v_and_b32 v41, 0xffff0000, v60
    v_lshlrev_b32 v42, 16, v61
    v_and_b32 v43, 0xffff0000, v61
    v_lshlrev_b32 v44, 16, v62
    v_and_b32 v45, 0xffff0000, v62
    v_lshlrev_b32 v46, 16, v63
    v_and_b32 v47, 0xffff0000, v63
    v_lshlrev_b32 v48, 16, v64
    v_and_b32 v49, 0xffff0000, v64
    v_lshlrev_b32 v50, 16, v65
    v_and_b32 v51, 0xffff0000, v65
    v_lshlrev_b32 v52, 16, v66
    v_and_b32 v53, 0xffff0000, v66
    v_lshlrev_b32 v54, 16, v67
    v_and_b32 v55, 0xffff0000, v67
    v_mul_f32 v40, v40, v21
    v_mul_f32 v41, v41, v21
    v_mul_f32 v42, v42, v21
    v_mul_f32 v43, v43, v21
    v_mul_f32 v44, v44, v21
    v_mul_f32 v45, v45, v21
    v_mul_f32 v46, v46, v21
    v_mul_f32 v47, v47, v21
    v_mul_f32 v48, v48, v21
    v_mul_f32 v49, v49, v21
    v_mul_f32 v50, v50, v21
    v_mul_f32 v51, v51, v21
    v_mul_f32 v52, v52, v21
    v_mul_f32 v53, v53, v21
    v_mul_f32 v54, v54, v21
    v_mul_f32 v55, v55, v21
    v_cvt_pk_bf16_f32 v60, v40, v41
    v_cvt_pk_bf16_f32 v61, v42, v43
    v_cvt_pk_bf16_f32 v62, v44, v45
    v_cvt_pk_bf16_f32 v63, v46, v47
    v_cvt_pk_bf16_f32 v64, v48, v49
    v_cvt_pk_bf16_f32 v65, v50, v51
    v_cvt_pk_bf16_f32 v66, v52, v53
    v_cvt_pk_bf16_f32 v67, v54, v55
    s_mul_i32 s3, s6, 2560
    s_add_u32 s3, s3, 68640
    v_mul_u32_u24 v22, 320, v17
    v_lshl_add_u32 v22, v18, 4, v22
    v_add_u32 v22, s3, v22
    ds_write_b128 v22, v[60:63]
    ds_write_b128 v22, v[64:67] offset:128
    s_cmp_lg_u32 s6, 0
    s_cbranch_scc1 L_pn1
    global_load_dword v224, v225, s[44:45] sc1
L_pn1:
    s_waitcnt lgkmcnt(0)
    s_barrier
    ds_read_b64_tr_b16 v[84:85], v80 offset:0
    ds_read_b64_tr_b16 v[86:87], v80 offset:1280
    ds_read_b64_tr_b16 v[88:89], v80 offset:5120
    ds_read_b64_tr_b16 v[90:91], v80 offset:6400
    s_lshl_b32 s3, s12, 10
    s_lshl_b32 s13, s11, 4
    s_add_u32 s3, s3, s13
    v_mov_b32 v28, s3
    s_waitcnt lgkmcnt(0)
    global_store_dwordx4 v92, v[84:87], s[56:57] sc1
    global_store_dwordx4 v92, v[88:91], s[56:57] offset:32 sc1
    s_waitcnt vmcnt(0)
    s_barrier
    s_cmp_lg_u32 s6, 0
    s_cbranch_scc1 L_pn4
    s_mov_b32 s94, 0
L_pn2:
    v_cmp_eq_u32 vcc, 0, v224
    s_add_u32 s94, s94, 1
    s_cmp_gt_u32 s94, 0x200000
    s_cbranch_scc1 L_pn3
    s_cbranch_vccz L_pn3
    s_sleep 2
    global_load_dword v224, v225, s[44:45] sc1
    s_waitcnt vmcnt(0)
    s_branch L_pn2
L_pn3:
    v_cmp_eq_u32 vcc, 0, v0
    s_and_saveexec_b64 s[58:59], vcc
    global_store_dword v28, v224, s[90:91] sc1
    s_mov_b64 exec, s[58:59]
L_pn4:
    s_cmp_lg_u32 s71, 0
    s_cbranch_scc1 L_wd0
    buffer_load_dword v229, v228, s[52:55], s70 offen
L_wd0:
    v_lshlrev_b32 v7, 4, v1
    s_mul_i32 s12, s7, 4608
    s_add_u32 s12, s12, 68640
    s_lshl_b32 s13, s9, 12
    s_lshl_b32 s3, s8, 11
    s_add_u32 s13, s13, s3
    s_add_u32 s11, s12, s3
    s_add_u32 s11, s11, 480
    s_mul_i32 s15, s7, 1360
    s_add_u32 s15, s15, 77872
    v_mov_b32 v88, 0
    v_mov_b32 v89, 0
    v_mov_b32 v90, 0
    v_mov_b32 v91, 0
    v_add_u32 v92, s12, v7
    v_mov_b32 v4, v226
    v_cmp_gt_u32 vcc, 30, v1
    s_and_saveexec_b64 s[58:59], vcc
    ds_write_b128 v92, v[88:91]
    s_mov_b64 exec, s[58:59]
    s_lshr_b32 s3, s4, 1
    s_lshl_b32 s3, s3, 10
    v_add_u32 v227, s3, v7
    v_add_u32 v230, s13, v7
    v_add_u32 v231, s11, v7
    s_mov_b32 s64, 0x3fb8aa3b
    v_mul_f32 v30, s64, v16
    v_fma_f32 v31, v16, s64, -v30
    v_fmac_f32 v31, 0x32a57060, v16
    v_exp_f32 v30, v30
    v_mul_f32 v31, 0x3f317218, v31
    v_fma_f32 v30, v30, v31, v30
    v_cvt_pk_bf16_f32 v30, v30, v30
    v_and_b32 v30, 0xffff0000, v30
    v_mul_f32 v10, v30, v10
    v_mul_f32 v11, v30, v11
    v_mul_f32 v12, v30, v12
    v_mul_f32 v13, v30, v13
    v_mul_f32 v10, s64, v10
    v_mul_f32 v11, 0.15915494, v11
    v_mul_f32 v32, v14, v12
    v_mul_f32 v33, v14, v13
    v_fma_f32 v32, -v15, v13, v32
    v_fmac_f32 v33, v15, v12
    v_mul_f32 v76, 0x3f800000, v10
    v_mul_f32 v77, 0x3f800000, v11
    v_mul_f32 v80, 0x42000000, v10
    v_mul_f32 v81, 0x42000000, v11
    v_mul_f32 v84, 0x44000000, v10
    v_mul_f32 v85, 0x44000000, v11
    v_exp_f32 v76, v76
    v_fract_f32 v77, v77
    v_exp_f32 v80, v80
    v_fract_f32 v81, v81
    v_exp_f32 v84, v84
    v_fract_f32 v85, v85
    v_cos_f32 v78, v77
    v_sin_f32 v79, v77
    v_cos_f32 v82, v81
    v_sin_f32 v83, v81
    v_cos_f32 v86, v85
    v_sin_f32 v87, v85
    s_mul_i32 s14, s7, 34320
    s_lshl_b32 s3, s8, 8
    s_add_u32 s3, s3, s14
    v_lshl_add_u32 v8, v1, 2, s3
    v_mul_f32 v34, v76, v78
    v_mul_f32 v35, v76, v79
    v_mul_f32 v36, v80, v82
    v_mul_f32 v37, v80, v83
    v_mul_f32 v38, v84, v86
    v_mul_f32 v39, v84, v87
    v_mul_f32 v40, v34, v34
    v_mul_f32 v41, v34, v35
    v_fma_f32 v40, -v35, v35, v40
    v_fmac_f32 v41, v35, v34
    v_mul_f32 v42, v40, v40
    v_mul_f32 v43, v40, v41
    v_fma_f32 v42, -v41, v41, v42
    v_fmac_f32 v43, v41, v40
    v_mul_f32 v44, v42, v42
    v_mul_f32 v45, v42, v43
    v_fma_f32 v44, -v43, v43, v44
    v_fmac_f32 v45, v43, v42
    v_mov_b32 v76, 0x3f80
    ds_write_b32 v8, v76 offset:25872
    v_mul_f32 v58, v32, v34
    v_mul_f32 v62, v32, v38
    v_mul_f32 v59, v32, v35
    v_mul_f32 v63, v32, v39
    v_fma_f32 v58, -v33, v35, v58
    v_fma_f32 v62, -v33, v39, v62
    v_fmac_f32 v59, v33, v34
    v_fmac_f32 v63, v33, v38
    v_cvt_pk_bf16_f32 v72, v36, v37
    v_cvt_pk_bf16_f32 v73, v32, -v33
    v_cvt_pk_bf16_f32 v74, v58, -v59
    v_cvt_pk_bf16_f32 v75, v62, -v63
    ds_write_b32 v8, v72 offset:26400
    ds_write_b32 v8, v73 offset:0
    ds_write_b32 v8, v74 offset:528
    ds_write_b32 v8, v75 offset:16896
    v_mul_f32 v50, v36, v36
    v_mul_f32 v56, v32, v40
    v_mul_f32 v60, v58, v40
    v_mul_f32 v70, v62, v42
    v_mul_f32 v51, v36, v37
    v_mul_f32 v57, v32, v41
    v_mul_f32 v61, v58, v41
    v_mul_f32 v71, v62, v43
    v_fma_f32 v50, -v37, v37, v50
    v_fma_f32 v56, -v33, v41, v56
    v_fma_f32 v60, -v59, v41, v60
    v_fma_f32 v70, -v63, v43, v70
    v_fmac_f32 v51, v37, v36
    v_fmac_f32 v57, v33, v40
    v_fmac_f32 v61, v59, v40
    v_fmac_f32 v71, v63, v42
    v_cvt_pk_bf16_f32 v72, v50, v51
    v_cvt_pk_bf16_f32 v73, v56, -v57
    v_cvt_pk_bf16_f32 v74, v60, -v61
    v_cvt_pk_bf16_f32 v75, v70, -v71
    ds_write_b32 v8, v72 offset:26928
    ds_write_b32 v8, v73 offset:1056
    ds_write_b32 v8, v74 offset:1584
    ds_write_b32 v8, v75 offset:17424
    v_mul_f32 v52, v50, v36
    v_mul_f32 v54, v56, v40
    v_mul_f32 v58, v60, v40
    v_mul_f32 v68, v70, v42
    v_mul_f32 v53, v50, v37
    v_mul_f32 v55, v56, v41
    v_mul_f32 v59, v60, v41
    v_mul_f32 v69, v70, v43
    v_fma_f32 v52, -v51, v37, v52
    v_fma_f32 v54, -v57, v41, v54
    v_fma_f32 v58, -v61, v41, v58
    v_fma_f32 v68, -v71, v43, v68
    v_fmac_f32 v53, v51, v36
    v_fmac_f32 v55, v57, v40
    v_fmac_f32 v59, v61, v40
    v_fmac_f32 v69, v71, v42
    v_cvt_pk_bf16_f32 v72, v52, v53
    v_cvt_pk_bf16_f32 v73, v54, -v55
    v_cvt_pk_bf16_f32 v74, v58, -v59
    v_cvt_pk_bf16_f32 v75, v68, -v69
    ds_write_b32 v8, v72 offset:27456
    ds_write_b32 v8, v73 offset:2112
    ds_write_b32 v8, v74 offset:2640
    ds_write_b32 v8, v75 offset:17952
    v_mul_f32 v50, v52, v36
    v_mul_f32 v56, v54, v40
    v_mul_f32 v60, v58, v40
    v_mul_f32 v70, v68, v42
    v_mul_f32 v51, v52, v37
    v_mul_f32 v57, v54, v41
    v_mul_f32 v61, v58, v41
    v_mul_f32 v71, v68, v43
    v_fma_f32 v50, -v53, v37, v50
    v_fma_f32 v56, -v55, v41, v56
    v_fma_f32 v60, -v59, v41, v60
    v_fma_f32 v70, -v69, v43, v70
    v_fmac_f32 v51, v53, v36
    v_fmac_f32 v57, v55, v40
    v_fmac_f32 v61, v59, v40
    v_fmac_f32 v71, v69, v42
    v_cvt_pk_bf16_f32 v72, v50, v51
    v_cvt_pk_bf16_f32 v73, v56, -v57
    v_cvt_pk_bf16_f32 v74, v60, -v61
    v_cvt_pk_bf16_f32 v75, v70, -v71
    ds_write_b32 v8, v72 offset:27984
    ds_write_b32 v8, v73 offset:3168
    ds_write_b32 v8, v74 offset:3696
    ds_write_b32 v8, v75 offset:18480
    v_mul_f32 v52, v50, v36
    v_mul_f32 v54, v56, v40
    v_mul_f32 v58, v60, v40
    v_mul_f32 v68, v70, v42
    v_mul_f32 v53, v50, v37
    v_mul_f32 v55, v56, v41
    v_mul_f32 v59, v60, v41
    v_mul_f32 v69, v70, v43
    v_fma_f32 v52, -v51, v37, v52
    v_fma_f32 v54, -v57, v41, v54
    v_fma_f32 v58, -v61, v41, v58
    v_fma_f32 v68, -v71, v43, v68
    v_fmac_f32 v53, v51, v36
    v_fmac_f32 v55, v57, v40
    v_fmac_f32 v59, v61, v40
    v_fmac_f32 v69, v71, v42
    v_cvt_pk_bf16_f32 v72, v52, v53
    v_cvt_pk_bf16_f32 v73, v54, -v55
    v_cvt_pk_bf16_f32 v74, v58, -v59
    v_cvt_pk_bf16_f32 v75, v68, -v69
    ds_write_b32 v8, v72 offset:28512
    ds_write_b32 v8, v73 offset:4224
    ds_write_b32 v8, v74 offset:4752
    ds_write_b32 v8, v75 offset:19008
    v_mul_f32 v50, v52, v36
    v_mul_f32 v56, v54, v40
    v_mul_f32 v60, v58, v40
    v_mul_f32 v70, v68, v42
    v_mul_f32 v51, v52, v37
    v_mul_f32 v57, v54, v41
    v_mul_f32 v61, v58, v41
    v_mul_f32 v71, v68, v43
    v_fma_f32 v50, -v53, v37, v50
    v_fma_f32 v56, -v55, v41, v56
    v_fma_f32 v60, -v59, v41, v60
    v_fma_f32 v70, -v69, v43, v70
    v_fmac_f32 v51, v53, v36
    v_fmac_f32 v57, v55, v40
    v_fmac_f32 v61, v59, v40
    v_fmac_f32 v71, v69, v42
    v_cvt_pk_bf16_f32 v72, v50, v51
    v_cvt_pk_bf16_f32 v73, v56, -v57
    v_cvt_pk_bf16_f32 v74, v60, -v61
    v_cvt_pk_bf16_f32 v75, v70, -v71
    ds_write_b32 v8, v72 offset:29040
    ds_write_b32 v8, v73 offset:5280
    ds_write_b32 v8, v74 offset:5808
    ds_write_b32 v8, v75 offset:19536
    s_cmp_lg_u32 s71, 1
    s_cbranch_scc1 L_wd1
    buffer_load_dword v229, v228, s[52:55], s70 offen
L_wd1:
    v_mul_f32 v52, v50, v36
    v_mul_f32 v54, v56, v40
    v_mul_f32 v58, v60, v40
    v_mul_f32 v68, v70, v42
    v_mul_f32 v53, v50, v37
    v_mul_f32 v55, v56, v41
    v_mul_f32 v59, v60, v41
    v_mul_f32 v69, v70, v43
    v_fma_f32 v52, -v51, v37, v52
    v_fma_f32 v54, -v57, v41, v54
    v_fma_f32 v58, -v61, v41, v58
    v_fma_f32 v68, -v71, v43, v68
    v_fmac_f32 v53, v51, v36
    v_fmac_f32 v55, v57, v40
    v_fmac_f32 v59, v61, v40
    v_fmac_f32 v69, v71, v42
    v_cvt_pk_bf16_f32 v72, v52, v53
    v_cvt_pk_bf16_f32 v73, v54, -v55
    v_cvt_pk_bf16_f32 v74, v58, -v59
    v_cvt_pk_bf16_f32 v75, v68, -v69
    ds_write_b32 v8, v72 offset:29568
    ds_write_b32 v8, v73 offset:6336
    ds_write_b32 v8, v74 offset:6864
    ds_write_b32 v8, v75 offset:20064
    v_mul_f32 v50, v52, v36
    v_mul_f32 v56, v54, v40
    v_mul_f32 v60, v58, v40
    v_mul_f32 v70, v68, v42
    v_mul_f32 v51, v52, v37
    v_mul_f32 v57, v54, v41
    v_mul_f32 v61, v58, v41
    v_mul_f32 v71, v68, v43
    v_fma_f32 v50, -v53, v37, v50
    v_fma_f32 v56, -v55, v41, v56
    v_fma_f32 v60, -v59, v41, v60
    v_fma_f32 v70, -v69, v43, v70
    v_fmac_f32 v51, v53, v36
    v_fmac_f32 v57, v55, v40
    v_fmac_f32 v61, v59, v40
    v_fmac_f32 v71, v69, v42
    v_cvt_pk_bf16_f32 v72, v50, v51
    v_cvt_pk_bf16_f32 v73, v56, -v57
    v_cvt_pk_bf16_f32 v74, v60, -v61
    v_cvt_pk_bf16_f32 v75, v70, -v71
    ds_write_b32 v8, v72 offset:30096
    ds_write_b32 v8, v73 offset:7392
    ds_write_b32 v8, v74 offset:7920
    ds_write_b32 v8, v75 offset:20592
    v_mul_f32 v52, v50, v36
    v_mul_f32 v54, v56, v40
    v_mul_f32 v58, v60, v40
    v_mul_f32 v64, v62, v38
    v_mul_f32 v53, v50, v37
    v_mul_f32 v55, v56, v41
    v_mul_f32 v59, v60, v41
    v_mul_f32 v65, v62, v39
    v_fma_f32 v52, -v51, v37, v52
    v_fma_f32 v54, -v57, v41, v54
    v_fma_f32 v58, -v61, v41, v58
    v_fma_f32 v64, -v63, v39, v64
    v_fmac_f32 v53, v51, v36
    v_fmac_f32 v55, v57, v40
    v_fmac_f32 v59, v61, v40
    v_fmac_f32 v65, v63, v38
    v_cvt_pk_bf16_f32 v72, v52, v53
    v_cvt_pk_bf16_f32 v73, v54, -v55
    v_cvt_pk_bf16_f32 v74, v58, -v59
    v_cvt_pk_bf16_f32 v75, v64, -v65
    ds_write_b32 v8, v72 offset:30624
    ds_write_b32 v8, v73 offset:8448
    ds_write_b32 v8, v74 offset:8976
    ds_write_b32 v8, v75 offset:21120
    v_mul_f32 v50, v52, v36
    v_mul_f32 v56, v54, v40
    v_mul_f32 v60, v58, v40
    v_mul_f32 v70, v64, v44
    v_mul_f32 v51, v52, v37
    v_mul_f32 v57, v54, v41
    v_mul_f32 v61, v58, v41
    v_mul_f32 v71, v64, v45
    v_fma_f32 v50, -v53, v37, v50
    v_fma_f32 v56, -v55, v41, v56
    v_fma_f32 v60, -v59, v41, v60
    v_fma_f32 v70, -v65, v45, v70
    v_fmac_f32 v51, v53, v36
    v_fmac_f32 v57, v55, v40
    v_fmac_f32 v61, v59, v40
    v_fmac_f32 v71, v65, v44
    v_cvt_pk_bf16_f32 v72, v50, v51
    v_cvt_pk_bf16_f32 v73, v56, -v57
    v_cvt_pk_bf16_f32 v74, v60, -v61
    v_cvt_pk_bf16_f32 v75, v70, -v71
    ds_write_b32 v8, v72 offset:31152
    ds_write_b32 v8, v73 offset:9504
    ds_write_b32 v8, v74 offset:10032
    ds_write_b32 v8, v75 offset:21648
    v_mul_f32 v52, v50, v36
    v_mul_f32 v54, v56, v40
    v_mul_f32 v58, v60, v40
    v_mul_f32 v68, v70, v44
    v_mul_f32 v53, v50, v37
    v_mul_f32 v55, v56, v41
    v_mul_f32 v59, v60, v41
    v_mul_f32 v69, v70, v45
    v_fma_f32 v52, -v51, v37, v52
    v_fma_f32 v54, -v57, v41, v54
    v_fma_f32 v58, -v61, v41, v58
    v_fma_f32 v68, -v71, v45, v68
    v_fmac_f32 v53, v51, v36
    v_fmac_f32 v55, v57, v40
    v_fmac_f32 v59, v61, v40
    v_fmac_f32 v69, v71, v44
    v_cvt_pk_bf16_f32 v72, v52, v53
    v_cvt_pk_bf16_f32 v73, v54, -v55
    v_cvt_pk_bf16_f32 v74, v58, -v59
    v_cvt_pk_bf16_f32 v75, v68, -v69
    ds_write_b32 v8, v72 offset:31680
    ds_write_b32 v8, v73 offset:10560
    ds_write_b32 v8, v74 offset:11088
    ds_write_b32 v8, v75 offset:22176
    v_mul_f32 v50, v52, v36
    v_mul_f32 v56, v54, v40
    v_mul_f32 v60, v58, v40
    v_mul_f32 v70, v68, v44
    v_mul_f32 v51, v52, v37
    v_mul_f32 v57, v54, v41
    v_mul_f32 v61, v58, v41
    v_mul_f32 v71, v68, v45
    v_fma_f32 v50, -v53, v37, v50
    v_fma_f32 v56, -v55, v41, v56
    v_fma_f32 v60, -v59, v41, v60
    v_fma_f32 v70, -v69, v45, v70
    v_fmac_f32 v51, v53, v36
    v_fmac_f32 v57, v55, v40
    v_fmac_f32 v61, v59, v40
    v_fmac_f32 v71, v69, v44
    v_cvt_pk_bf16_f32 v72, v50, v51
    v_cvt_pk_bf16_f32 v73, v56, -v57
    v_cvt_pk_bf16_f32 v74, v60, -v61
    v_cvt_pk_bf16_f32 v75, v70, -v71
    ds_write_b32 v8, v72 offset:32208
    ds_write_b32 v8, v73 offset:11616
    ds_write_b32 v8, v74 offset:12144
    ds_write_b32 v8, v75 offset:22704
    s_cmp_lg_u32 s71, 2
    s_cbranch_scc1 L_wd2
    buffer_load_dword v229, v228, s[52:55], s70 offen
L_wd2:
    v_mul_f32 v52, v50, v36
    v_mul_f32 v54, v56, v40
    v_mul_f32 v58, v60, v40
    v_mul_f32 v66, v64, v38
    v_mul_f32 v53, v50, v37
    v_mul_f32 v55, v56, v41
    v_mul_f32 v59, v60, v41
    v_mul_f32 v67, v64, v39
    v_fma_f32 v52, -v51, v37, v52
    v_fma_f32 v54, -v57, v41, v54
    v_fma_f32 v58, -v61, v41, v58
    v_fma_f32 v66, -v65, v39, v66
    v_fmac_f32 v53, v51, v36
    v_fmac_f32 v55, v57, v40
    v_fmac_f32 v59, v61, v40
    v_fmac_f32 v67, v65, v38
    v_cvt_pk_bf16_f32 v72, v52, v53
    v_cvt_pk_bf16_f32 v73, v54, -v55
    v_cvt_pk_bf16_f32 v74, v58, -v59
    v_cvt_pk_bf16_f32 v75, v66, -v67
    ds_write_b32 v8, v72 offset:32736
    ds_write_b32 v8, v73 offset:12672
    ds_write_b32 v8, v74 offset:13200
    ds_write_b32 v8, v75 offset:23232
    v_mul_f32 v50, v52, v36
    v_mul_f32 v56, v54, v40
    v_mul_f32 v60, v58, v40
    v_mul_f32 v70, v66, v44
    v_mul_f32 v51, v52, v37
    v_mul_f32 v57, v54, v41
    v_mul_f32 v61, v58, v41
    v_mul_f32 v71, v66, v45
    v_fma_f32 v50, -v53, v37, v50
    v_fma_f32 v56, -v55, v41, v56
    v_fma_f32 v60, -v59, v41, v60
    v_fma_f32 v70, -v67, v45, v70
    v_fmac_f32 v51, v53, v36
    v_fmac_f32 v57, v55, v40
    v_fmac_f32 v61, v59, v40
    v_fmac_f32 v71, v67, v44
    v_cvt_pk_bf16_f32 v72, v50, v51
    v_cvt_pk_bf16_f32 v73, v56, -v57
    v_cvt_pk_bf16_f32 v74, v60, -v61
    v_cvt_pk_bf16_f32 v75, v70, -v71
    ds_write_b32 v8, v72 offset:33264
    ds_write_b32 v8, v73 offset:13728
    ds_write_b32 v8, v74 offset:14256
    ds_write_b32 v8, v75 offset:23760
    v_mul_f32 v52, v50, v36
    v_mul_f32 v54, v56, v40
    v_mul_f32 v58, v60, v40
    v_mul_f32 v68, v70, v44
    v_mul_f32 v53, v50, v37
    v_mul_f32 v55, v56, v41
    v_mul_f32 v59, v60, v41
    v_mul_f32 v69, v70, v45
    v_fma_f32 v52, -v51, v37, v52
    v_fma_f32 v54, -v57, v41, v54
    v_fma_f32 v58, -v61, v41, v58
    v_fma_f32 v68, -v71, v45, v68
    v_fmac_f32 v53, v51, v36
    v_fmac_f32 v55, v57, v40
    v_fmac_f32 v59, v61, v40
    v_fmac_f32 v69, v71, v44
    v_cvt_pk_bf16_f32 v72, v52, v53
    v_cvt_pk_bf16_f32 v73, v54, -v55
    v_cvt_pk_bf16_f32 v74, v58, -v59
    v_cvt_pk_bf16_f32 v75, v68, -v69
    ds_write_b32 v8, v72 offset:33792
    ds_write_b32 v8, v73 offset:14784
    ds_write_b32 v8, v74 offset:15312
    ds_write_b32 v8, v75 offset:24288
    v_mul_f32 v56, v54, v40
    v_mul_f32 v60, v58, v40
    v_mul_f32 v70, v68, v44
    v_mul_f32 v57, v54, v41
    v_mul_f32 v61, v58, v41
    v_mul_f32 v71, v68, v45
    v_fma_f32 v56, -v55, v41, v56
    v_fma_f32 v60, -v59, v41, v60
    v_fma_f32 v70, -v69, v45, v70
    v_fmac_f32 v57, v55, v40
    v_fmac_f32 v61, v59, v40
    v_fmac_f32 v71, v69, v44
    v_cvt_pk_bf16_f32 v72, v56, -v57
    v_cvt_pk_bf16_f32 v73, v60, -v61
    v_cvt_pk_bf16_f32 v74, v70, -v71
    ds_write_b32 v8, v72 offset:15840
    ds_write_b32 v8, v73 offset:16368
    ds_write_b32 v8, v74 offset:24816
    v_mul_f32 v68, v66, v38
    v_mul_f32 v69, v66, v39
    v_fma_f32 v68, -v67, v39, v68
    v_fmac_f32 v69, v67, v38
    v_cvt_pk_bf16_f32 v72, v68, -v69
    ds_write_b32 v8, v72 offset:25344
    s_cmp_lg_u32 s71, 3
    s_cbranch_scc1 L_wd3
    buffer_load_dword v229, v228, s[52:55], s70 offen
L_wd3:
    s_cmp_lg_u32 s6, 0
    s_cbranch_scc1 L_cq
    global_load_dword v224, v225, s[44:45] sc1
    global_load_dword v208, v227, s[90:91] sc1
    s_mov_b32 s94, 0
L_c2_p:
    s_waitcnt vmcnt(0)
    v_cmp_ne_u32 vcc, v208, v224
    v_cmp_eq_u32 s[92:93], 0, v224
    s_add_u32 s94, s94, 1
    s_cmp_gt_u32 s94, 0x200000
    s_cbranch_scc1 L_c2_d
    s_or_b64 vcc, vcc, s[92:93]
    s_cbranch_vccz L_c2_d
    s_sleep 4
    global_load_dword v224, v225, s[44:45] sc1
    global_load_dword v208, v227, s[90:91] sc1
    s_branch L_c2_p
L_c2_d:
L_cq:
    v_and_b32 v92, 15, v1
    v_lshrrev_b32 v93, 4, v1
    v_mul_u32_u24 v94, 528, v92
    v_lshl_add_u32 v94, v93, 4, v94
    v_add_u32 v94, s14, v94
    s_mul_i32 s3, s8, 16896
    v_add_u32 v95, s3, v94
    v_add_u32 v96, 8448, v94
    s_add_u32 s3, s14, 25344
    v_lshl_add_u32 v97, v93, 4, s3
    s_cmp_eq_u32 s8, 0
    s_cselect_b64 vcc, -1, 0
    s_nop 0
    v_cndmask_b32 v96, v97, v96, vcc
    s_waitcnt lgkmcnt(0)
    s_barrier
    global_load_dwordx4 v[200:203], v230, s[56:57] sc1
    global_load_dwordx4 v[204:207], v230, s[56:57] offset:1024 sc1
    ds_read_b128 v[100:103], v94 offset:25872
    ds_read_b128 v[104:107], v95 offset:0
    ds_read_b128 v[108:111], v96 offset:0
    ds_read_b128 v[112:115], v94 offset:25936
    ds_read_b128 v[116:119], v95 offset:64
    ds_read_b128 v[120:123], v96 offset:64
    ds_read_b128 v[124:127], v94 offset:26000
    ds_read_b128 v[128:131], v95 offset:128
    ds_read_b128 v[132:135], v96 offset:128
    ds_read_b128 v[136:139], v94 offset:26064
    ds_read_b128 v[140:143], v95 offset:192
    ds_read_b128 v[144:147], v96 offset:192
    ds_read_b128 v[148:151], v94 offset:26128
    ds_read_b128 v[152:155], v95 offset:256
    ds_read_b128 v[156:159], v96 offset:256
    ds_read_b128 v[160:163], v94 offset:26192
    ds_read_b128 v[164:167], v95 offset:320
    ds_read_b128 v[168:171], v96 offset:320
    ds_read_b128 v[172:175], v94 offset:26256
    ds_read_b128 v[176:179], v95 offset:384
    ds_read_b128 v[180:183], v96 offset:384
    ds_read_b128 v[184:187], v94 offset:26320
    ds_read_b128 v[188:191], v95 offset:448
    ds_read_b128 v[192:195], v96 offset:448
    s_waitcnt lgkmcnt(15)
    v_mfma_f32_16x16x32_bf16 v[20:23], v[104:107], v[100:103], 0
    v_mfma_f32_16x16x32_bf16 v[24:27], v[108:111], v[100:103], 0
    s_waitcnt lgkmcnt(15)
    v_mfma_f32_16x16x32_bf16 v[20:23], v[116:119], v[112:115], v[20:23]
    v_mfma_f32_16x16x32_bf16 v[24:27], v[120:123], v[112:115], v[24:27]
    s_waitcnt lgkmcnt(15)
    v_mfma_f32_16x16x32_bf16 v[20:23], v[128:131], v[124:127], v[20:23]
    v_mfma_f32_16x16x32_bf16 v[24:27], v[132:135], v[124:127], v[24:27]
    s_waitcnt lgkmcnt(12)
    v_mfma_f32_16x16x32_bf16 v[20:23], v[140:143], v[136:139], v[20:23]
    v_mfma_f32_16x16x32_bf16 v[24:27], v[144:147], v[136:139], v[24:27]
    s_waitcnt lgkmcnt(9)
    v_mfma_f32_16x16x32_bf16 v[20:23], v[152:155], v[148:151], v[20:23]
    v_mfma_f32_16x16x32_bf16 v[24:27], v[156:159], v[148:151], v[24:27]
    s_waitcnt lgkmcnt(6)
    v_mfma_f32_16x16x32_bf16 v[20:23], v[164:167], v[160:163], v[20:23]
    v_mfma_f32_16x16x32_bf16 v[24:27], v[168:171], v[160:163], v[24:27]
    s_waitcnt lgkmcnt(3)
    v_mfma_f32_16x16x32_bf16 v[20:23], v[176:179], v[172:175], v[20:23]
    v_mfma_f32_16x16x32_bf16 v[24:27], v[180:183], v[172:175], v[24:27]
    s_waitcnt lgkmcnt(0)
    v_mfma_f32_16x16x32_bf16 v[20:23], v[188:191], v[184:187], v[20:23]
    v_mfma_f32_16x16x32_bf16 v[24:27], v[192:195], v[184:187], v[24:27]
    v_lshlrev_b32 v80, 5, v92
    v_lshl_add_u32 v80, v93, 2, v80
    s_nop 4
    s_cmp_eq_u32 s8, 0
    s_cbranch_scc0 L_pT1
    v_cvt_pk_bf16_f32 v28, v20, v21
    v_cvt_pk_bf16_f32 v29, v22, v23
    v_cvt_pk_bf16_f32 v30, v20, v22
    v_cvt_pk_bf16_f32 v32, v24, v25
    v_cvt_pk_bf16_f32 v33, v26, v27
    v_cvt_pk_bf16_f32 v34, v24, v26
    v_lshl_add_u32 v81, v80, 1, s15
    v_add_u32 v82, s15, v80
    v_cmp_gt_u32 vcc, 8, v92
    s_and_saveexec_b64 s[58:59], vcc
    ds_write_b64 v81, v[28:29]
    ds_write_b64 v81, v[32:33] offset:32
    s_andn2_b64 exec, s[58:59], exec
    ds_write_b32 v82, v30 offset:256
    ds_write_b32 v82, v34 offset:272
    s_mov_b64 exec, s[58:59]
    s_branch L_pT2
L_pT1:
    v_cvt_pk_bf16_f32 v28, v20, v21
    v_cvt_pk_bf16_f32 v29, v22, v23
    v_cvt_pk_bf16_f32 v30, v24, v24
    v_lshlrev_b32 v81, 3, v92
    v_lshl_add_u32 v81, v93, 2, v81
    v_lshlrev_b32 v82, 2, v92
    v_lshl_add_u32 v82, v93, 6, v82
    v_cmp_gt_u32 vcc, 2, v93
    s_add_u32 s3, s15, 768
    v_mov_b32 v83, s15
    v_cndmask_b32 v81, v82, v81, vcc
    v_lshl_add_u32 v81, v81, 1, s3
    ds_write_b64 v81, v[28:29]
    v_cmp_eq_u32 vcc, 0, v1
    s_and_saveexec_b64 s[58:59], vcc
    ds_write_b16 v83, v30 offset:1280
    s_mov_b64 exec, s[58:59]
L_pT2:
    s_mov_b32 s66, 0x01000100
    s_mov_b32 s67, 0x03020302
    s_mov_b32 s68, 0x01000302
    s_mov_b32 s69, 0x03020504
    v_lshl_add_u32 v80, v1, 2, s15
    s_waitcnt lgkmcnt(0)
    s_barrier
    s_cmp_eq_u32 s8, 0
    s_cbranch_scc0 L_pE1
    ds_read2_b32 v[20:21], v80 offset0:192 offset1:193
    v_and_b32 v81, 31, v1
    v_lshlrev_b32 v82, 3, v81
    v_add_u32 v82, 512, v82
    v_lshlrev_b32 v83, 4, v81
    v_cmp_gt_u32 vcc, 32, v1
    s_add_u32 s3, s14, 3056
    v_sub_u32 v84, s3, v7
    v_cndmask_b32 v82, v83, v82, vcc
    v_add_u32 v82, s15, v82
    ds_read2_b32 v[24:25], v82 offset0:0 offset1:1
    ds_read2_b32 v[26:27], v82 offset0:2 offset1:3
    s_add_u32 s3, s14, 3568
    v_sub_u32 v85, s3, v83
    v_add_u32 v86, 512, v85
    v_cndmask_b32 v85, v86, v85, vcc
    s_waitcnt lgkmcnt(2)
    v_perm_b32 v28, v21, v21, s66
    v_perm_b32 v29, v20, v20, s67
    v_perm_b32 v30, v20, v20, s68
    v_perm_b32 v31, v20, v20, s66
    ds_write_b128 v84, v[28:31]
    s_waitcnt lgkmcnt(1)
    v_perm_b32 v32, v27, v27, s68
    v_perm_b32 v33, v26, v26, s68
    v_perm_b32 v34, v25, v25, s68
    v_perm_b32 v35, v24, v24, s68
    s_and_saveexec_b64 s[58:59], vcc
    v_perm_b32 v32, v26, v25, s69
    v_perm_b32 v33, v25, v25, s66
    v_perm_b32 v34, v25, v24, s69
    v_perm_b32 v35, v24, v24, s66
    s_mov_b64 exec, s[58:59]
    ds_write_b128 v85, v[32:35]
    s_branch L_pE2
L_pE1:
    v_add_u32 v81, 1024, v80
    ds_read2_b32 v[20:21], v81 offset0:0 offset1:1
    v_lshlrev_b32 v84, 5, v1
    s_add_u32 s3, s14, 2016
    v_sub_u32 v84, s3, v84
    v_lshrrev_b32 v85, 2, v1
    v_mul_u32_u24 v85, 4160, v85
    v_and_b32 v86, 3, v1
    v_lshl_add_u32 v85, v86, 4, v85
    s_add_u32 s3, s14, 4096
    v_add_u32 v85, s3, v85
    v_cmp_gt_u32 vcc, 16, v1
    s_and_saveexec_b64 s[58:59], vcc
    ds_write_b128 v85, v[88:91]
    s_mov_b64 exec, s[58:59]
    s_waitcnt lgkmcnt(1)
    v_perm_b32 v28, v21, v21, s66
    v_perm_b32 v30, v20, v20, s67
    v_perm_b32 v34, v20, v20, s66
    v_perm_b32 v33, v20, v20, s68
    v_mov_b32 v29, v28
    v_mov_b32 v31, v30
    v_mov_b32 v32, v30
    v_mov_b32 v35, v34
    ds_write_b128 v84, v[28:31]
    ds_write_b128 v84, v[32:35] offset:16
L_pE2:
    s_lshl_b32 s3, s8, 10
    s_add_u32 s3, s3, s14
    v_add_u32 v80, s3, v7
    s_add_u32 s60, s46, 13631488
    s_addc_u32 s61, s47, 0
    v_lshlrev_b32 v8, 5, v92
    v_lshl_add_u32 v8, v93, 3, v8
    v_add_u32 v9, s11, v8
    v_add_u32 v42, s13, v8
    v_add_u32 v81, 2048, v80
    s_waitcnt lgkmcnt(0)
    s_barrier
    ds_read_b128 v[48:51], v80
    ds_read2_b32 v[52:53], v80 offset0:1 offset1:2
    ds_read2_b32 v[54:55], v80 offset0:3 offset1:4
    ds_read_b32 v56, v80 offset:20
    ds_read_b128 v[60:63], v81
    ds_read2_b32 v[64:65], v81 offset0:1 offset1:2
    ds_read2_b32 v[66:67], v81 offset0:3 offset1:4
    ds_read_b32 v68, v81 offset:20
    v_sub_u32 v12, 3, v92
    v_and_b32 v12, 3, v12
    v_mul_u32_u24 v2, 4158, v12
    v_lshlrev_b32 v13, 3, v93
    v_sub_u32 v13, v13, v92
    v_add_u32 v13, 239, v13
    v_lshl_add_u32 v2, v13, 1, v2
    s_lshl_b32 s3, s8, 6
    s_sub_u32 s10, s14, s3
    v_add_u32 v2, s10, v2
    v_lshl_add_u32 v3, v93, 3, v8
    s_sub_u32 s3, s12, s3
    s_add_u32 s3, s3, 448
    v_add_u32 v3, s3, v3
    s_waitcnt lgkmcnt(4)
    ds_write_b128 v80, v[52:55] offset:8320
    v_alignbit_b32 v104, v49, v48, 16
    v_alignbit_b32 v105, v50, v49, 16
    v_alignbit_b32 v106, v51, v50, 16
    v_alignbit_b32 v107, v55, v51, 16
    v_mov_b32 v108, v105
    v_mov_b32 v109, v106
    v_mov_b32 v110, v107
    v_alignbit_b32 v111, v56, v55, 16
    ds_write_b128 v80, v[104:107] offset:4160
    ds_write_b128 v80, v[108:111] offset:12480
    s_waitcnt lgkmcnt(3)
    ds_write_b128 v81, v[64:67] offset:8320
    v_alignbit_b32 v112, v61, v60, 16
    v_alignbit_b32 v113, v62, v61, 16
    v_alignbit_b32 v114, v63, v62, 16
    v_alignbit_b32 v115, v67, v63, 16
    v_mov_b32 v116, v113
    v_mov_b32 v117, v114
    v_mov_b32 v118, v115
    v_alignbit_b32 v119, v68, v67, 16
    ds_write_b128 v81, v[112:115] offset:4160
    ds_write_b128 v81, v[116:119] offset:12480
    s_waitcnt vmcnt(0)
    ds_write_b128 v231, v[200:203]
    ds_write_b128 v231, v[204:207] offset:1024
    s_waitcnt lgkmcnt(0)
    s_barrier
    ds_read_b64 v[48:49], v2 offset:3584
    ds_read_b64 v[50:51], v2 offset:3592
    ds_read_b128 v[80:83], v3 offset:0
    ds_read_b128 v[84:87], v3 offset:512
    ds_read_b128 v[88:91], v3 offset:1024
    ds_read_b128 v[92:95], v3 offset:1536
    ds_read_b128 v[96:99], v3 offset:2048
    ds_read_b128 v[100:103], v3 offset:2560
    ds_read_b128 v[104:107], v3 offset:3072
    ds_read_b128 v[108:111], v3 offset:3584
    ds_read_b64 v[52:53], v2 offset:3072
    ds_read_b64 v[54:55], v2 offset:3080
    ds_read_b64 v[56:57], v2 offset:2560
    ds_read_b64 v[58:59], v2 offset:2568
    ds_read_b64 v[60:61], v2 offset:2048
    ds_read_b64 v[62:63], v2 offset:2056
    ds_read_b64 v[64:65], v2 offset:1536
    ds_read_b64 v[66:67], v2 offset:1544
    ds_read_b64 v[68:69], v2 offset:1024
    ds_read_b64 v[70:71], v2 offset:1032
    ds_read_b64 v[72:73], v2 offset:512
    ds_read_b64 v[74:75], v2 offset:520
    ds_read_b64 v[76:77], v2 offset:0
    ds_read_b64 v[78:79], v2 offset:8
    ds_read_b64 v[176:177], v9 offset:0
    ds_read_b64 v[178:179], v9 offset:512
    ds_read_b64 v[180:181], v9 offset:1024
    ds_read_b64 v[182:183], v9 offset:1536
    v_subrev_u32 v2, 128, v2
    v_subrev_u32 v3, 128, v3
    s_waitcnt lgkmcnt(15)
    v_mfma_f32_16x16x32_bf16 v[10:13], v[48:51], v[80:83], 0
    v_mfma_f32_16x16x32_bf16 v[14:17], v[48:51], v[84:87], 0
    v_mfma_f32_16x16x32_bf16 v[18:21], v[48:51], v[88:91], 0
    s_waitcnt lgkmcnt(15)
    v_mfma_f32_16x16x32_bf16 v[22:25], v[48:51], v[92:95], 0
    s_waitcnt lgkmcnt(15)
    v_mfma_f32_16x16x32_bf16 v[26:29], v[48:51], v[96:99], 0
    s_waitcnt lgkmcnt(15)
    v_mfma_f32_16x16x32_bf16 v[30:33], v[48:51], v[100:103], 0
    s_waitcnt lgkmcnt(15)
    v_mfma_f32_16x16x32_bf16 v[34:37], v[48:51], v[104:107], 0
    s_waitcnt lgkmcnt(15)
    v_mfma_f32_16x16x32_bf16 v[38:41], v[48:51], v[108:111], 0
    s_waitcnt lgkmcnt(0)
    v_mfma_f32_16x16x32_bf16 v[14:17], v[52:55], v[80:83], v[14:17]
    ds_read_b64 v[112:113], v2 offset:3584
    v_mfma_f32_16x16x32_bf16 v[18:21], v[52:55], v[84:87], v[18:21]
    ds_read_b64 v[114:115], v2 offset:3592
    v_mfma_f32_16x16x32_bf16 v[22:25], v[52:55], v[88:91], v[22:25]
    ds_read_b128 v[144:147], v3 offset:0
    v_mfma_f32_16x16x32_bf16 v[26:29], v[52:55], v[92:95], v[26:29]
    ds_read_b64 v[116:117], v2 offset:3072
    v_mfma_f32_16x16x32_bf16 v[30:33], v[52:55], v[96:99], v[30:33]
    ds_read_b64 v[118:119], v2 offset:3080
    v_mfma_f32_16x16x32_bf16 v[34:37], v[52:55], v[100:103], v[34:37]
    ds_read_b128 v[148:151], v3 offset:512
    v_mfma_f32_16x16x32_bf16 v[38:41], v[52:55], v[104:107], v[38:41]
    ds_read_b64 v[120:121], v2 offset:2560
    v_mfma_f32_16x16x32_bf16 v[18:21], v[56:59], v[80:83], v[18:21]
    ds_read_b64 v[122:123], v2 offset:2568
    v_mfma_f32_16x16x32_bf16 v[22:25], v[56:59], v[84:87], v[22:25]
    ds_read_b128 v[152:155], v3 offset:1024
    v_mfma_f32_16x16x32_bf16 v[26:29], v[56:59], v[88:91], v[26:29]
    ds_read_b64 v[124:125], v2 offset:2048
    v_mfma_f32_16x16x32_bf16 v[30:33], v[56:59], v[92:95], v[30:33]
    ds_read_b64 v[126:127], v2 offset:2056
    v_mfma_f32_16x16x32_bf16 v[34:37], v[56:59], v[96:99], v[34:37]
    ds_read_b128 v[156:159], v3 offset:1536
    v_mfma_f32_16x16x32_bf16 v[38:41], v[56:59], v[100:103], v[38:41]
    ds_read_b64 v[128:129], v2 offset:1536
    v_mfma_f32_16x16x32_bf16 v[22:25], v[60:63], v[80:83], v[22:25]
    ds_read_b64 v[130:131], v2 offset:1544
    v_mfma_f32_16x16x32_bf16 v[26:29], v[60:63], v[84:87], v[26:29]
    ds_read_b128 v[160:163], v3 offset:2048
    v_mfma_f32_16x16x32_bf16 v[30:33], v[60:63], v[88:91], v[30:33]
    ds_read_b64 v[132:133], v2 offset:1024
    v_mfma_f32_16x16x32_bf16 v[34:37], v[60:63], v[92:95], v[34:37]
    ds_read_b64 v[134:135], v2 offset:1032
    v_mfma_f32_16x16x32_bf16 v[38:41], v[60:63], v[96:99], v[38:41]
    ds_read_b128 v[164:167], v3 offset:2560
    v_mfma_f32_16x16x32_bf16 v[26:29], v[64:67], v[80:83], v[26:29]
    ds_read_b64 v[136:137], v2 offset:512
    v_mfma_f32_16x16x32_bf16 v[30:33], v[64:67], v[84:87], v[30:33]
    ds_read_b64 v[138:139], v2 offset:520
    v_mfma_f32_16x16x32_bf16 v[34:37], v[64:67], v[88:91], v[34:37]
    ds_read_b128 v[168:171], v3 offset:3072
    v_mfma_f32_16x16x32_bf16 v[38:41], v[64:67], v[92:95], v[38:41]
    ds_read_b64 v[140:141], v2 offset:0
    v_mfma_f32_16x16x32_bf16 v[30:33], v[68:71], v[80:83], v[30:33]
    ds_read_b64 v[142:143], v2 offset:8
    v_mfma_f32_16x16x32_bf16 v[34:37], v[68:71], v[84:87], v[34:37]
    ds_read_b128 v[172:175], v3 offset:3584
    v_mfma_f32_16x16x32_bf16 v[38:41], v[68:71], v[88:91], v[38:41]
    v_mfma_f32_16x16x32_bf16 v[34:37], v[72:75], v[80:83], v[34:37]
    v_mfma_f32_16x16x32_bf16 v[38:41], v[72:75], v[84:87], v[38:41]
    v_mfma_f32_16x16x32_bf16 v[38:41], v[76:79], v[80:83], v[38:41]
    s_waitcnt lgkmcnt(0)
    v_subrev_u32 v2, 128, v2
    v_subrev_u32 v3, 128, v3
    v_mfma_f32_16x16x32_bf16 v[10:13], v[112:115], v[144:147], v[10:13]
    ds_read_b64 v[48:49], v2 offset:3584
    v_mfma_f32_16x16x32_bf16 v[14:17], v[112:115], v[148:151], v[14:17]
    ds_read_b64 v[50:51], v2 offset:3592
    v_mfma_f32_16x16x32_bf16 v[18:21], v[112:115], v[152:155], v[18:21]
    ds_read_b128 v[80:83], v3 offset:0
    v_mfma_f32_16x16x32_bf16 v[22:25], v[112:115], v[156:159], v[22:25]
    ds_read_b64 v[52:53], v2 offset:3072
    v_mfma_f32_16x16x32_bf16 v[26:29], v[112:115], v[160:163], v[26:29]
    ds_read_b64 v[54:55], v2 offset:3080
    v_mfma_f32_16x16x32_bf16 v[30:33], v[112:115], v[164:167], v[30:33]
    ds_read_b128 v[84:87], v3 offset:512
    v_mfma_f32_16x16x32_bf16 v[34:37], v[112:115], v[168:171], v[34:37]
    ds_read_b64 v[56:57], v2 offset:2560
    v_mfma_f32_16x16x32_bf16 v[38:41], v[112:115], v[172:175], v[38:41]
    ds_read_b64 v[58:59], v2 offset:2568
    v_mfma_f32_16x16x32_bf16 v[14:17], v[116:119], v[144:147], v[14:17]
    ds_read_b128 v[88:91], v3 offset:1024
    v_mfma_f32_16x16x32_bf16 v[18:21], v[116:119], v[148:151], v[18:21]
    ds_read_b64 v[60:61], v2 offset:2048
    v_mfma_f32_16x16x32_bf16 v[22:25], v[116:119], v[152:155], v[22:25]
    ds_read_b64 v[62:63], v2 offset:2056
    v_mfma_f32_16x16x32_bf16 v[26:29], v[116:119], v[156:159], v[26:29]
    ds_read_b128 v[92:95], v3 offset:1536
    v_mfma_f32_16x16x32_bf16 v[30:33], v[116:119], v[160:163], v[30:33]
    ds_read_b64 v[64:65], v2 offset:1536
    v_mfma_f32_16x16x32_bf16 v[34:37], v[116:119], v[164:167], v[34:37]
    ds_read_b64 v[66:67], v2 offset:1544
    v_mfma_f32_16x16x32_bf16 v[38:41], v[116:119], v[168:171], v[38:41]
    ds_read_b128 v[96:99], v3 offset:2048
    v_mfma_f32_16x16x32_bf16 v[18:21], v[120:123], v[144:147], v[18:21]
    ds_read_b64 v[68:69], v2 offset:1024
    v_mfma_f32_16x16x32_bf16 v[22:25], v[120:123], v[148:151], v[22:25]
    ds_read_b64 v[70:71], v2 offset:1032
    v_mfma_f32_16x16x32_bf16 v[26:29], v[120:123], v[152:155], v[26:29]
    ds_read_b128 v[100:103], v3 offset:2560
    v_mfma_f32_16x16x32_bf16 v[30:33], v[120:123], v[156:159], v[30:33]
    ds_read_b64 v[72:73], v2 offset:512
    v_mfma_f32_16x16x32_bf16 v[34:37], v[120:123], v[160:163], v[34:37]
    ds_read_b64 v[74:75], v2 offset:520
    v_mfma_f32_16x16x32_bf16 v[38:41], v[120:123], v[164:167], v[38:41]
    ds_read_b128 v[104:107], v3 offset:3072
    v_mfma_f32_16x16x32_bf16 v[22:25], v[124:127], v[144:147], v[22:25]
    ds_read_b64 v[76:77], v2 offset:0
    v_mfma_f32_16x16x32_bf16 v[26:29], v[124:127], v[148:151], v[26:29]
    ds_read_b64 v[78:79], v2 offset:8
    v_mfma_f32_16x16x32_bf16 v[30:33], v[124:127], v[152:155], v[30:33]
    ds_read_b128 v[108:111], v3 offset:3584
    v_mfma_f32_16x16x32_bf16 v[34:37], v[124:127], v[156:159], v[34:37]
    v_mfma_f32_16x16x32_bf16 v[38:41], v[124:127], v[160:163], v[38:41]
    v_mfma_f32_16x16x32_bf16 v[26:29], v[128:131], v[144:147], v[26:29]
    v_mfma_f32_16x16x32_bf16 v[30:33], v[128:131], v[148:151], v[30:33]
    v_mfma_f32_16x16x32_bf16 v[34:37], v[128:131], v[152:155], v[34:37]
    v_mfma_f32_16x16x32_bf16 v[38:41], v[128:131], v[156:159], v[38:41]
    v_mfma_f32_16x16x32_bf16 v[30:33], v[132:135], v[144:147], v[30:33]
    v_mfma_f32_16x16x32_bf16 v[34:37], v[132:135], v[148:151], v[34:37]
    v_mfma_f32_16x16x32_bf16 v[38:41], v[132:135], v[152:155], v[38:41]
    v_mfma_f32_16x16x32_bf16 v[34:37], v[136:139], v[144:147], v[34:37]
    v_mfma_f32_16x16x32_bf16 v[38:41], v[136:139], v[148:151], v[38:41]
    v_mfma_f32_16x16x32_bf16 v[38:41], v[140:143], v[144:147], v[38:41]
    s_waitcnt lgkmcnt(0)
    v_subrev_u32 v2, 128, v2
    v_subrev_u32 v3, 128, v3
    v_mfma_f32_16x16x32_bf16 v[10:13], v[48:51], v[80:83], v[10:13]
    ds_read_b64 v[112:113], v2 offset:3584
    v_mfma_f32_16x16x32_bf16 v[14:17], v[48:51], v[84:87], v[14:17]
    ds_read_b64 v[114:115], v2 offset:3592
    v_mfma_f32_16x16x32_bf16 v[18:21], v[48:51], v[88:91], v[18:21]
    ds_read_b128 v[144:147], v3 offset:0
    v_mfma_f32_16x16x32_bf16 v[22:25], v[48:51], v[92:95], v[22:25]
    ds_read_b64 v[116:117], v2 offset:3072
    v_mfma_f32_16x16x32_bf16 v[26:29], v[48:51], v[96:99], v[26:29]
    ds_read_b64 v[118:119], v2 offset:3080
    v_mfma_f32_16x16x32_bf16 v[30:33], v[48:51], v[100:103], v[30:33]
    ds_read_b128 v[148:151], v3 offset:512
    v_mfma_f32_16x16x32_bf16 v[34:37], v[48:51], v[104:107], v[34:37]
    ds_read_b64 v[120:121], v2 offset:2560
    v_mfma_f32_16x16x32_bf16 v[38:41], v[48:51], v[108:111], v[38:41]
    ds_read_b64 v[122:123], v2 offset:2568
    v_mfma_f32_16x16x32_bf16 v[14:17], v[52:55], v[80:83], v[14:17]
    ds_read_b128 v[152:155], v3 offset:1024
    v_mfma_f32_16x16x32_bf16 v[18:21], v[52:55], v[84:87], v[18:21]
    ds_read_b64 v[124:125], v2 offset:2048
    v_mfma_f32_16x16x32_bf16 v[22:25], v[52:55], v[88:91], v[22:25]
    ds_read_b64 v[126:127], v2 offset:2056
    v_mfma_f32_16x16x32_bf16 v[26:29], v[52:55], v[92:95], v[26:29]
    ds_read_b128 v[156:159], v3 offset:1536
    v_mfma_f32_16x16x32_bf16 v[30:33], v[52:55], v[96:99], v[30:33]
    ds_read_b64 v[128:129], v2 offset:1536
    v_mfma_f32_16x16x32_bf16 v[34:37], v[52:55], v[100:103], v[34:37]
    ds_read_b64 v[130:131], v2 offset:1544
    v_mfma_f32_16x16x32_bf16 v[38:41], v[52:55], v[104:107], v[38:41]
    ds_read_b128 v[160:163], v3 offset:2048
    v_mfma_f32_16x16x32_bf16 v[18:21], v[56:59], v[80:83], v[18:21]
    ds_read_b64 v[132:133], v2 offset:1024
    v_mfma_f32_16x16x32_bf16 v[22:25], v[56:59], v[84:87], v[22:25]
    ds_read_b64 v[134:135], v2 offset:1032
    v_mfma_f32_16x16x32_bf16 v[26:29], v[56:59], v[88:91], v[26:29]
    ds_read_b128 v[164:167], v3 offset:2560
    v_mfma_f32_16x16x32_bf16 v[30:33], v[56:59], v[92:95], v[30:33]
    ds_read_b64 v[136:137], v2 offset:512
    v_mfma_f32_16x16x32_bf16 v[34:37], v[56:59], v[96:99], v[34:37]
    ds_read_b64 v[138:139], v2 offset:520
    v_mfma_f32_16x16x32_bf16 v[38:41], v[56:59], v[100:103], v[38:41]
    ds_read_b128 v[168:171], v3 offset:3072
    v_mfma_f32_16x16x32_bf16 v[22:25], v[60:63], v[80:83], v[22:25]
    ds_read_b64 v[140:141], v2 offset:0
    v_mfma_f32_16x16x32_bf16 v[26:29], v[60:63], v[84:87], v[26:29]
    ds_read_b64 v[142:143], v2 offset:8
    v_mfma_f32_16x16x32_bf16 v[30:33], v[60:63], v[88:91], v[30:33]
    ds_read_b128 v[172:175], v3 offset:3584
    v_mfma_f32_16x16x32_bf16 v[34:37], v[60:63], v[92:95], v[34:37]
    v_mfma_f32_16x16x32_bf16 v[38:41], v[60:63], v[96:99], v[38:41]
    v_mfma_f32_16x16x32_bf16 v[26:29], v[64:67], v[80:83], v[26:29]
    v_mfma_f32_16x16x32_bf16 v[30:33], v[64:67], v[84:87], v[30:33]
    v_mfma_f32_16x16x32_bf16 v[34:37], v[64:67], v[88:91], v[34:37]
    v_mfma_f32_16x16x32_bf16 v[38:41], v[64:67], v[92:95], v[38:41]
    v_mfma_f32_16x16x32_bf16 v[30:33], v[68:71], v[80:83], v[30:33]
    v_mfma_f32_16x16x32_bf16 v[34:37], v[68:71], v[84:87], v[34:37]
    v_mfma_f32_16x16x32_bf16 v[38:41], v[68:71], v[88:91], v[38:41]
    v_mfma_f32_16x16x32_bf16 v[34:37], v[72:75], v[80:83], v[34:37]
    v_mfma_f32_16x16x32_bf16 v[38:41], v[72:75], v[84:87], v[38:41]
    v_mfma_f32_16x16x32_bf16 v[38:41], v[76:79], v[80:83], v[38:41]
    s_waitcnt lgkmcnt(0)
    v_mfma_f32_16x16x32_bf16 v[10:13], v[112:115], v[144:147], v[10:13]
    v_lshlrev_b32 v196, 16, v176
    v_and_b32 v197, 0xffff0000, v176
    v_mfma_f32_16x16x32_bf16 v[14:17], v[112:115], v[148:151], v[14:17]
    v_lshlrev_b32 v198, 16, v177
    v_and_b32 v199, 0xffff0000, v177
    v_mfma_f32_16x16x32_bf16 v[18:21], v[112:115], v[152:155], v[18:21]
    v_mul_f32 v196, v196, v4
    v_mul_f32 v197, v197, v4
    v_mfma_f32_16x16x32_bf16 v[22:25], v[112:115], v[156:159], v[22:25]
    v_mul_f32 v198, v198, v4
    v_mul_f32 v199, v199, v4
    v_mfma_f32_16x16x32_bf16 v[26:29], v[112:115], v[160:163], v[26:29]
    v_cvt_pk_bf16_f32 v176, v196, v197
    v_cvt_pk_bf16_f32 v177, v198, v199
    v_mfma_f32_16x16x32_bf16 v[30:33], v[112:115], v[164:167], v[30:33]
    v_lshlrev_b32 v204, 16, v176
    v_and_b32 v205, 0xffff0000, v176
    v_mfma_f32_16x16x32_bf16 v[34:37], v[112:115], v[168:171], v[34:37]
    v_lshlrev_b32 v206, 16, v177
    v_and_b32 v207, 0xffff0000, v177
    v_mfma_f32_16x16x32_bf16 v[38:41], v[112:115], v[172:175], v[38:41]
    v_lshlrev_b32 v200, 16, v178
    v_and_b32 v201, 0xffff0000, v178
    v_mfma_f32_16x16x32_bf16 v[14:17], v[116:119], v[144:147], v[14:17]
    v_lshlrev_b32 v202, 16, v179
    v_and_b32 v203, 0xffff0000, v179
    v_mfma_f32_16x16x32_bf16 v[18:21], v[116:119], v[148:151], v[18:21]
    v_mul_f32 v200, v200, v4
    v_mul_f32 v201, v201, v4
    v_mfma_f32_16x16x32_bf16 v[22:25], v[116:119], v[152:155], v[22:25]
    v_mul_f32 v202, v202, v4
    v_mul_f32 v203, v203, v4
    v_mfma_f32_16x16x32_bf16 v[26:29], v[116:119], v[156:159], v[26:29]
    v_cvt_pk_bf16_f32 v178, v200, v201
    v_cvt_pk_bf16_f32 v179, v202, v203
    v_mfma_f32_16x16x32_bf16 v[30:33], v[116:119], v[160:163], v[30:33]
    v_lshlrev_b32 v208, 16, v178
    v_and_b32 v209, 0xffff0000, v178
    v_mfma_f32_16x16x32_bf16 v[34:37], v[116:119], v[164:167], v[34:37]
    v_lshlrev_b32 v210, 16, v179
    v_and_b32 v211, 0xffff0000, v179
    v_mfma_f32_16x16x32_bf16 v[38:41], v[116:119], v[168:171], v[38:41]
    v_lshlrev_b32 v196, 16, v180
    v_and_b32 v197, 0xffff0000, v180
    v_mfma_f32_16x16x32_bf16 v[18:21], v[120:123], v[144:147], v[18:21]
    v_lshlrev_b32 v198, 16, v181
    v_and_b32 v199, 0xffff0000, v181
    v_mfma_f32_16x16x32_bf16 v[22:25], v[120:123], v[148:151], v[22:25]
    v_mul_f32 v196, v196, v4
    v_mul_f32 v197, v197, v4
    v_mfma_f32_16x16x32_bf16 v[26:29], v[120:123], v[152:155], v[26:29]
    v_mul_f32 v198, v198, v4
    v_mul_f32 v199, v199, v4
    v_mfma_f32_16x16x32_bf16 v[30:33], v[120:123], v[156:159], v[30:33]
    v_cvt_pk_bf16_f32 v180, v196, v197
    v_cvt_pk_bf16_f32 v181, v198, v199
    v_mfma_f32_16x16x32_bf16 v[34:37], v[120:123], v[160:163], v[34:37]
    v_lshlrev_b32 v212, 16, v180
    v_and_b32 v213, 0xffff0000, v180
    v_mfma_f32_16x16x32_bf16 v[38:41], v[120:123], v[164:167], v[38:41]
    v_lshlrev_b32 v214, 16, v181
    v_and_b32 v215, 0xffff0000, v181
    v_mfma_f32_16x16x32_bf16 v[22:25], v[124:127], v[144:147], v[22:25]
    v_lshlrev_b32 v200, 16, v182
    v_and_b32 v201, 0xffff0000, v182
    v_mfma_f32_16x16x32_bf16 v[26:29], v[124:127], v[148:151], v[26:29]
    v_lshlrev_b32 v202, 16, v183
    v_and_b32 v203, 0xffff0000, v183
    v_mfma_f32_16x16x32_bf16 v[30:33], v[124:127], v[152:155], v[30:33]
    v_mul_f32 v200, v200, v4
    v_mul_f32 v201, v201, v4
    v_mfma_f32_16x16x32_bf16 v[34:37], v[124:127], v[156:159], v[34:37]
    v_mul_f32 v202, v202, v4
    v_mul_f32 v203, v203, v4
    v_mfma_f32_16x16x32_bf16 v[38:41], v[124:127], v[160:163], v[38:41]
    v_cvt_pk_bf16_f32 v182, v200, v201
    v_cvt_pk_bf16_f32 v183, v202, v203
    v_mfma_f32_16x16x32_bf16 v[26:29], v[128:131], v[144:147], v[26:29]
    v_lshlrev_b32 v216, 16, v182
    v_and_b32 v217, 0xffff0000, v182
    v_mfma_f32_16x16x32_bf16 v[30:33], v[128:131], v[148:151], v[30:33]
    v_lshlrev_b32 v218, 16, v183
    v_and_b32 v219, 0xffff0000, v183
    v_mfma_f32_16x16x32_bf16 v[34:37], v[128:131], v[152:155], v[34:37]
    v_mfma_f32_16x16x32_bf16 v[38:41], v[128:131], v[156:159], v[38:41]
    v_mfma_f32_16x16x32_bf16 v[30:33], v[132:135], v[144:147], v[30:33]
    v_mfma_f32_16x16x32_bf16 v[34:37], v[132:135], v[148:151], v[34:37]
    v_mfma_f32_16x16x32_bf16 v[38:41], v[132:135], v[152:155], v[38:41]
    v_mfma_f32_16x16x32_bf16 v[34:37], v[136:139], v[144:147], v[34:37]
    v_mfma_f32_16x16x32_bf16 v[38:41], v[136:139], v[148:151], v[38:41]
    v_mfma_f32_16x16x32_bf16 v[38:41], v[140:143], v[144:147], v[38:41]
    s_setprio 3
    s_lshl_b32 s3, s8, 12
    s_add_u32 s10, s14, 16640
    s_add_u32 s3, s3, s10
    v_add_u32 v2, s3, v7
    s_xor_b32 s3, s8, 1
    s_lshl_b32 s3, s3, 12
    s_add_u32 s3, s3, s10
    v_add_u32 v3, s3, v7
    s_nop 3
    s_cmp_eq_u32 s8, 0
    s_cbranch_scc0 L_cR1
    ds_write_b128 v2, v[26:29] offset:0
    ds_write_b128 v2, v[30:33] offset:1024
    ds_write_b128 v2, v[34:37] offset:2048
    ds_write_b128 v2, v[38:41] offset:3072
    v_mov_b32 v48, v10
    v_mov_b32 v49, v11
    v_mov_b32 v50, v12
    v_mov_b32 v51, v13
    v_mov_b32 v52, v14
    v_mov_b32 v53, v15
    v_mov_b32 v54, v16
    v_mov_b32 v55, v17
    v_mov_b32 v56, v18
    v_mov_b32 v57, v19
    v_mov_b32 v58, v20
    v_mov_b32 v59, v21
    v_mov_b32 v60, v22
    v_mov_b32 v61, v23
    v_mov_b32 v62, v24
    v_mov_b32 v63, v25
    s_branch L_cR2
L_cR1:
    ds_write_b128 v2, v[10:13] offset:0
    ds_write_b128 v2, v[14:17] offset:1024
    ds_write_b128 v2, v[18:21] offset:2048
    ds_write_b128 v2, v[22:25] offset:3072
    v_mov_b32 v48, v26
    v_mov_b32 v49, v27
    v_mov_b32 v50, v28
    v_mov_b32 v51, v29
    v_mov_b32 v52, v30
    v_mov_b32 v53, v31
    v_mov_b32 v54, v32
    v_mov_b32 v55, v33
    v_mov_b32 v56, v34
    v_mov_b32 v57, v35
    v_mov_b32 v58, v36
    v_mov_b32 v59, v37
    v_mov_b32 v60, v38
    v_mov_b32 v61, v39
    v_mov_b32 v62, v40
    v_mov_b32 v63, v41
L_cR2:
    s_waitcnt lgkmcnt(0)
    s_barrier
    ds_read_b128 v[64:67], v3 offset:0
    ds_read_b128 v[68:71], v3 offset:1024
    ds_read_b128 v[72:75], v3 offset:2048
    ds_read_b128 v[76:79], v3 offset:3072
    s_waitcnt lgkmcnt(3)
    v_add_f32 v48, v48, v64
    v_add_f32 v49, v49, v65
    v_add_f32 v50, v50, v66
    v_add_f32 v51, v51, v67
    v_cvt_pk_bf16_f32 v80, v48, v49
    v_cvt_pk_bf16_f32 v81, v50, v51
    v_lshlrev_b32 v48, 16, v80
    v_and_b32 v49, 0xffff0000, v80
    v_lshlrev_b32 v50, 16, v81
    v_and_b32 v51, 0xffff0000, v81
    v_add_f32 v48, v48, v204
    v_add_f32 v49, v49, v205
    v_add_f32 v50, v50, v206
    v_add_f32 v51, v51, v207
    v_cvt_pk_bf16_f32 v80, v48, v49
    v_cvt_pk_bf16_f32 v81, v50, v51
    global_store_dwordx2 v42, v[80:81], s[60:61] offset:0 sc1
    s_waitcnt lgkmcnt(2)
    v_add_f32 v52, v52, v68
    v_add_f32 v53, v53, v69
    v_add_f32 v54, v54, v70
    v_add_f32 v55, v55, v71
    v_cvt_pk_bf16_f32 v82, v52, v53
    v_cvt_pk_bf16_f32 v83, v54, v55
    v_lshlrev_b32 v52, 16, v82
    v_and_b32 v53, 0xffff0000, v82
    v_lshlrev_b32 v54, 16, v83
    v_and_b32 v55, 0xffff0000, v83
    v_add_f32 v52, v52, v208
    v_add_f32 v53, v53, v209
    v_add_f32 v54, v54, v210
    v_add_f32 v55, v55, v211
    v_cvt_pk_bf16_f32 v82, v52, v53
    v_cvt_pk_bf16_f32 v83, v54, v55
    global_store_dwordx2 v42, v[82:83], s[60:61] offset:512 sc1
    s_waitcnt lgkmcnt(1)
    v_add_f32 v56, v56, v72
    v_add_f32 v57, v57, v73
    v_add_f32 v58, v58, v74
    v_add_f32 v59, v59, v75
    v_cvt_pk_bf16_f32 v84, v56, v57
    v_cvt_pk_bf16_f32 v85, v58, v59
    v_lshlrev_b32 v56, 16, v84
    v_and_b32 v57, 0xffff0000, v84
    v_lshlrev_b32 v58, 16, v85
    v_and_b32 v59, 0xffff0000, v85
    v_add_f32 v56, v56, v212
    v_add_f32 v57, v57, v213
    v_add_f32 v58, v58, v214
    v_add_f32 v59, v59, v215
    v_cvt_pk_bf16_f32 v84, v56, v57
    v_cvt_pk_bf16_f32 v85, v58, v59
    global_store_dwordx2 v42, v[84:85], s[60:61] offset:1024 sc1
    s_waitcnt lgkmcnt(0)
    v_add_f32 v60, v60, v76
    v_add_f32 v61, v61, v77
    v_add_f32 v62, v62, v78
    v_add_f32 v63, v63, v79
    v_cvt_pk_bf16_f32 v86, v60, v61
    v_cvt_pk_bf16_f32 v87, v62, v63
    v_lshlrev_b32 v60, 16, v86
    v_and_b32 v61, 0xffff0000, v86
    v_lshlrev_b32 v62, 16, v87
    v_and_b32 v63, 0xffff0000, v87
    v_add_f32 v60, v60, v216
    v_add_f32 v61, v61, v217
    v_add_f32 v62, v62, v218
    v_add_f32 v63, v63, v219
    v_cvt_pk_bf16_f32 v86, v60, v61
    v_cvt_pk_bf16_f32 v87, v62, v63
    global_store_dwordx2 v42, v[86:87], s[60:61] offset:1536 sc1
    s_lshl_b32 s3, s4, 9
    s_lshl_b32 s13, s5, 4
    s_add_u32 s3, s3, s13
    s_add_u32 s3, s3, 16384
    v_mov_b32 v5, s3
    s_waitcnt vmcnt(0)
    s_barrier
    v_cmp_eq_u32 vcc, 0, v0
    s_and_saveexec_b64 s[58:59], vcc
    s_cbranch_execz L_end3
    global_store_dword v5, v224, s[90:91] sc1
L_end3:
    s_endpgm
.section .rodata,"a"
.p2align 6
.amdhsa_kernel parallel_sum__ssm_conv_s4__swiglu_ffn__prompt_kernel
  .amdhsa_next_free_vgpr 256
  .amdhsa_next_free_sgpr 102
  .amdhsa_accum_offset 256
  .amdhsa_group_segment_fixed_size 0
  .amdhsa_kernarg_size 128
  .amdhsa_user_sgpr_count 2
  .amdhsa_user_sgpr_kernarg_segment_ptr 1
  .amdhsa_system_sgpr_workgroup_id_x 1
.end_amdhsa_kernel
```
